```python
import torch

def _softmax(x, axis=-1):
    return torch.softmax(x, dim=axis)
def _gelu(x):
    return torch.nn.functional.gelu(x, approximate="tanh")
def _silu(x):
    return torch.nn.functional.silu(x)
def _sigmoid(x):
    return torch.sigmoid(x)
def _layernorm(x, axis=-1, eps=1e-5):
    m = x.mean(dim=axis, keepdim=True)
    v = x.var(dim=axis, keepdim=True, unbiased=False)
    return (x - m) / torch.sqrt(v + eps)
def _scatter_add(tgt, idx, src, axis=0):
    return tgt.clone().index_add_(axis, idx, src)
def _segment_sum(src, seg, n):
    out = torch.zeros((n,) + src.shape[1:], dtype=src.dtype)
    return out.index_add_(0, seg, src)
def _pad(x, pw):
    flat = tuple(v for pair in reversed(pw) for v in pair)
    return torch.nn.functional.pad(x, flat)

kernel_name = 'gated_mix__linear_attn_block__ssm_conv_s4__prompt'

def setup_inputs():

    _w = (lambda a: (lambda t: t.to(torch.bfloat16) if t.is_floating_point() else t)(torch.as_tensor(a)))
    def _A_setup():
        B, S, D = 1, 2048, 576
        return {
            "x": _w((lambda *s: torch.randn(*s, dtype=torch.bfloat16) * 0.05)(B, S, D)),
            "wqkv": _w((lambda *s: torch.randn(*s, dtype=torch.bfloat16) * 0.8)(D, 3 * D)),
            "wo": _w((lambda *s: torch.randn(*s, dtype=torch.bfloat16) * 0.05)(D, D)),
        }
    _A_in = _A_setup()

    def _B_setup():
        B, L, D, N = 1, 2048, 576, 128
        A_re = -(lambda _x: torch.exp(torch.as_tensor(_x)))((lambda *s: torch.randn(*s, dtype=torch.bfloat16) * 3.2)(D, N))
        A_im = torch.pi * (lambda *s: torch.randn(*s, dtype=torch.bfloat16) * 0.05)(D, N)
        B_re = (lambda *s: torch.randn(*s, dtype=torch.bfloat16) * 0.2)(D, N)
        B_im = (lambda *s: torch.randn(*s, dtype=torch.bfloat16) * 0.2)(D, N)
        C_re = (lambda *s: torch.randn(*s, dtype=torch.bfloat16) * 0.2)(D, N)
        C_im = (lambda *s: torch.randn(*s, dtype=torch.bfloat16) * 0.2)(D, N)
        log_dt = (lambda *s: torch.randn(*s, dtype=torch.bfloat16) * 0.05)(D) * 0.5 - 4.0
        Dskip = (lambda *s: torch.randn(*s, dtype=torch.bfloat16) * 0.05)(D)
        return {
            "u": _w((lambda *s: torch.randn(*s, dtype=torch.bfloat16) * 0.05)(B, L, D)),
            "A_re": _w(A_re),
            "A_im": _w(A_im),
            "B_re": _w(B_re),
            "B_im": _w(B_im),
            "C_re": _w(C_re),
            "C_im": _w(C_im),
            "log_dt": _w(log_dt),
            "Dskip": _w(Dskip),
        }
    _B_in = _B_setup()

    return {
        "A_x": _A_in["x"],
        "A_wqkv": _A_in["wqkv"],
        "A_wo": _A_in["wo"],
        "B_u": _B_in["u"],
        "B_A_re": _B_in["A_re"],
        "B_A_im": _B_in["A_im"],
        "B_B_re": _B_in["B_re"],
        "B_B_im": _B_in["B_im"],
        "B_C_re": _B_in["C_re"],
        "B_C_im": _B_in["C_im"],
        "B_log_dt": _B_in["log_dt"],
        "B_Dskip": _B_in["Dskip"],
        "gate_w": _w((lambda *s: torch.randn(*s, dtype=torch.bfloat16) * 0.05)(576) * 16.0),
    }

def reference(A_x, A_wqkv, A_wo, B_u, B_A_re, B_A_im, B_B_re, B_B_im, B_C_re, B_C_im, B_log_dt, B_Dskip, gate_w):
    def _A_ref(x, wqkv, wo):
        B, S, D = x.shape
        H = 32; Dh = D // H
        qkv = (lambda x, *d: x.permute(*d))((x @ wqkv).reshape(B, S, 3, H, Dh), 2, 0, 3, 1, 4)
        q, k, v = qkv[0], qkv[1], qkv[2]
        phi = lambda t: torch.where(t > 0, t + 1, torch.exp(t)) + 1e-6
        pq, pk = phi(q), phi(k)
        kv = torch.einsum("bhsd,bhse->bhde", pk, v)
        z = torch.einsum("bhsd->bhd", pk)
        num = torch.einsum("bhqd,bhde->bhqe", pq, kv)
        den = torch.einsum("bhqd,bhd->bhq", pq, z)[..., None] + 1e-6
        o = num / den
        return (lambda x, *d: x.permute(*d))(o, 0, 2, 1, 3).reshape(B, S, D) @ wo

    def _B_ref(u, A_re, A_im, B_re, B_im, C_re, C_im, log_dt, Dskip):
        Bsz, L, D = u.shape
        dt = torch.exp(log_dt)[:, None]
        A = A_re + 1j * A_im
        Bc = B_re + 1j * B_im
        Cc = C_re + 1j * C_im
        logdA = dt * A
        dB = dt * Bc
        l = (lambda x, dt: x.to(dt))(torch.arange(L), A_re.dtype)
        P = torch.exp(logdA[:, :, None] * l[None, None, :])
        K = torch.einsum("dn,dnl,dn->dl", Cc, P, dB).real
        L2 = 2 * L
        Kp = _pad(K, ((0, 0), (0, L)))
        up = (lambda x, *d: x.permute(*d))(u, 0, 2, 1)
        up = _pad(up, ((0, 0), (0, 0), (0, L)))
        Kf = (lambda x, axes=(-2,-1): torch.fft.rfft2(x.float(), dim=axes))(Kp[:, None, :], axes=(-2, -1))
        Uf = (lambda x, axes=(-2,-1): torch.fft.rfft2(x.float(), dim=axes))(up[:, :, None, :], axes=(-2, -1))
        Yf = Uf * Kf[None, :, :, :]
        y = (lambda x, s, axes=(-2,-1): torch.fft.irfft2(x, s=s, dim=axes).to(torch.bfloat16))(Yf, (1, L2), axes=(-2, -1))[:, :, 0, :L]
        y = (lambda x, *d: x.permute(*d))(y, 0, 2, 1) + u * Dskip[None, None, :]
        return y

    x = A_x
    g = _sigmoid((x * gate_w).sum(-1, keepdims=True))
    a = _A_ref(x, A_wqkv, A_wo)
    b = _B_ref(x, B_A_re, B_A_im, B_B_re, B_B_im, B_C_re, B_C_im, B_log_dt, B_Dskip)
    return g * a + (1 - g) * b
```

```asm
; @launch kernel=k1_kernel grid=(256,1,1) block=(768,1,1) lds=137728
; @launch kernel=k2_kernel grid=(256,1,1) block=(576,1,1) lds=128000
.amdgcn_target "amdgcn-amd-amdhsa--gfx950"
.text
.globl k1_kernel
.p2align 8
.type k1_kernel,@function
k1_kernel:
s_cmp_ge_u32 s2, 256
s_cbranch_scc1 K1_end
v_lshrrev_b32 v1, 6, v0
s_and_b32 s16, s2, 7
s_lshr_b32 s17, s2, 3
v_readfirstlane_b32 s20, v1
s_cmp_ge_u32 s17, 12
s_nop 3
s_cbranch_scc1 K1_notconv
s_mul_i32 s21, s16, 12
s_add_u32 s21, s21, s17
s_mov_b32 s18, 0
CV_entry:
s_setprio 3
s_load_dwordx16 s[36:51], s[0:1], 32
s_load_dwordx2 s[4:5], s[0:1], 0
s_load_dwordx2 s[6:7], s[0:1], 120
v_and_b32 v2, 63, v0
s_lshr_b32 s22, s20, 1
s_lshr_b32 s23, s20, 2
s_xor_b32 s23, s23, s20
s_and_b32 s23, s23, 1
s_mul_i32 s24, s21, 6
s_add_u32 s24, s24, s22
s_lshl_b32 s25, s24, 8
s_lshl_b32 s26, s23, 7
s_add_u32 s27, s25, s26
s_xor_b32 s26, s26, 128
s_add_u32 s28, s25, s26
v_lshlrev_b32 v33, 1, v2
v_add_u32 v34, s28, v33
v_add_u32 v33, s27, v33
s_lshl_b32 s25, s24, 1
v_mov_b32 v35, s25
v_and_b32 v3, 15, v0
v_lshrrev_b32 v4, 4, v2
v_lshlrev_b32 v17, 2, v2
v_add_u32 v17, 134144, v17
v_mov_b32 v19, 0
s_mul_i32 s56, s20, 4352
s_mov_b32 m0, s56
s_xor_b32 s57, s20, 1
s_and_b32 s60, s20, 14
s_mul_i32 s60, s60, 4352
s_add_u32 s60, s60, 52224
s_add_u32 s61, s60, 4352
s_lshl_b32 s62, s23, 6
s_mul_i32 s64, s22, 4608
s_add_u32 s64, s64, 104960
s_waitcnt lgkmcnt(0)
global_load_ushort v36, v35, s[48:49]
global_load_ushort v37, v35, s[50:51]
global_load_ushort v38, v33, s[36:37]
global_load_ushort v39, v33, s[38:39]
global_load_ushort v40, v33, s[40:41]
global_load_ushort v41, v33, s[42:43]
global_load_ushort v42, v33, s[44:45]
global_load_ushort v43, v33, s[46:47]
global_load_ushort v44, v34, s[40:41]
global_load_ushort v45, v34, s[42:43]
global_load_ushort v46, v34, s[44:45]
global_load_ushort v47, v34, s[46:47]
s_mov_b32 s8, s4
s_mov_b32 s9, s5
s_mov_b32 s10, 2359296
s_mov_b32 s11, 0x20000
s_mov_b32 s12, s6
s_mov_b32 s13, s7
s_mov_b32 s14, 5570560
s_mov_b32 s15, 0x20000
s_cmp_lt_u32 s20, 4
s_cbranch_scc1 CV_g2pre
s_sub_u32 s32, s22, 1
s_and_b32 s33, s20, 1
s_sub_u32 s33, s32, s33
s_sub_u32 s33, s33, 64
s_lshl_b32 s32, s32, 1
v_lshl_add_u32 v1, v2, 1, s33
v_cmp_ge_u32 vcc, s32, v1
v_mov_b32 v10, 0x3c00
s_nop 0
v_cndmask_b32 v5, 0, v10, vcc
v_add_u32 v1, 1, v1
v_cmp_ge_u32 vcc, s32, v1
v_mov_b32 v10, 0x3c000000
s_nop 0
v_cndmask_b32 v1, 0, v10, vcc
v_or_b32 v5, v5, v1
s_lshl_b32 s32, s20, 8
s_sub_u32 s32, s32, 3072
v_add_u32 v10, s32, v17
ds_write_b32 v10, v5
s_cmp_lg_u32 s20, 4
s_cbranch_scc1 CV_pc0
v_lshrrev_b32 v11, 1, v4
v_lshlrev_b32 v11, 5, v11
v_and_b32 v5, 1, v4
v_lshlrev_b32 v5, 4, v5
v_sub_u32 v1, v5, v11
v_lshlrev_b32 v11, 1, v3
v_sub_u32 v1, v1, v11
v_and_b32 v5, 1, v3
v_cmp_eq_u32 vcc, 0, v5
v_mov_b32 v10, 1346
s_nop 0
v_cndmask_b32 v10, 0, v10, vcc
v_add_u32 v10, v1, v10
ds_write_b32 v17, v19
ds_write_b32 v17, v10 offset:256
s_branch CV_pre_done
CV_pc0:
s_cmp_lg_u32 s20, 5
s_cbranch_scc1 CV_pc1
v_lshrrev_b32 v11, 1, v4
v_lshlrev_b32 v11, 5, v11
v_and_b32 v5, 1, v4
v_lshlrev_b32 v5, 4, v5
v_sub_u32 v1, v5, v11
v_lshl_add_u32 v10, v3, 5, v1
ds_write_b32 v17, v10 offset:512
s_nop 0
s_branch CV_pre_done
CV_pc1:
s_cmp_lg_u32 s20, 6
s_cbranch_scc1 CV_pc2
v_lshlrev_b32 v10, 4, v4
v_lshlrev_b32 v11, 1, v3
v_sub_u32 v10, v10, v11
v_and_b32 v5, 1, v3
v_mul_u32_u24 v5, 258, v5
v_add_u32 v10, v10, v5
v_add_u32 v10, 132200, v10
ds_write_b32 v17, v10 offset:768
s_nop 0
s_branch CV_pre_done
CV_pc2:
s_cmp_lg_u32 s20, 7
s_cbranch_scc1 CV_pc3
v_add_u32 v10, 1, v3
v_and_b32 v10, 3, v10
v_mul_u32_u24 v10, 930, v10
v_lshlrev_b32 v11, 1, v3
v_sub_u32 v10, v10, v11
v_lshl_add_u32 v10, v4, 3, v10
ds_write_b32 v17, v10 offset:1024
s_nop 0
s_branch CV_pre_done
CV_pc3:
s_cmp_lg_u32 s20, 8
s_cbranch_scc1 CV_pc4
v_add_u32 v11, 1, v3
v_cmp_eq_u32 vcc, 15, v3
s_nop 1
v_cndmask_b32 v11, v11, 32, vcc
v_add_u32 v5, 16, v2
v_cmp_eq_u32 vcc, 0, v4
s_nop 1
v_cndmask_b32 v11, v11, v5, vcc
v_lshlrev_b32 v10, 2, v11
ds_write_b32 v17, v10 offset:1280
s_nop 0
s_branch CV_pre_done
CV_pc4:
s_cmp_lg_u32 s20, 9
s_cbranch_scc1 CV_pc5
v_cmp_eq_u32 vcc, 32, v2
v_lshl_add_u32 v11, v3, 1, v4
s_nop 0
v_cndmask_b32 v11, v11, 32, vcc
v_lshlrev_b32 v10, 4, v11
ds_write_b32 v17, v10 offset:1536
s_nop 0
s_branch CV_pre_done
CV_pc5:
s_cmp_lg_u32 s20, 10
s_cbranch_scc1 CV_pc6
v_and_b32 v11, 3, v3
v_mul_u32_u24 v11, 144, v11
v_lshrrev_b32 v5, 2, v3
v_lshlrev_b32 v5, 5, v5
v_sub_u32 v11, v11, v5
v_add_u32 v11, 88, v11
v_and_b32 v5, 1, v3
v_mul_u32_u24 v5, 176, v5
v_lshrrev_b32 v1, 1, v3
v_lshlrev_b32 v1, 5, v1
v_sub_u32 v5, v5, v1
v_add_u32 v5, 824, v5
v_cmp_gt_u32 vcc, 8, v3
s_nop 1
v_cndmask_b32 v11, v5, v11, vcc
v_lshlrev_b32 v5, 3, v4
v_sub_u32 v10, v11, v5
ds_write_b32 v17, v10 offset:1792
s_nop 0
s_branch CV_pre_done
CV_pc6:
s_branch CV_pre_done
CV_g2pre:
s_mov_b32 s34, s20
s_add_u32 s32, s20, s17
s_and_b32 s32, s32, 3
v_lshl_add_u32 v33, s32, 6, v2
v_lshlrev_b32 v34, 4, v33
v_add_u32 v34, 104960, v34
v_mul_u32_u24 v33, 9216, v33
s_mul_i32 s31, s21, 12
s_add_u32 s35, s31, 4608
s_lshr_b32 s33, s17, 2
v_mov_b32 v20, 0
v_mov_b32 v21, 0
v_mov_b32 v22, 0
v_mov_b32 v23, 0
v_lshrrev_b32 v10, 5, v2
s_min_u32 s32, s34, 2
s_lshl_b32 s32, s32, 1
v_add_u32 v10, s32, v10
v_mul_u32_u24 v10, 4608, v10
v_and_b32 v11, 31, v2
v_lshl_add_u32 v10, v11, 4, v10
v_add_u32 v10, 104448, v10
ds_write_b128 v10, v[20:23]
s_nop 0
CV_pre_done:
v_mul_u32_u24 v32, 272, v3
v_lshl_add_u32 v32, v4, 4, v32
v_add_u32 v32, s56, v32
v_lshlrev_b32 v10, 4, v2
v_add_u32 v12, s56, v10
s_mul_i32 s58, s57, 4352
v_add_u32 v13, s58, v10
v_mov_b32 v19, 1
s_lshl_b32 s58, s20, 2
s_add_u32 s58, s58, 134144
v_mov_b32 v16, s58
s_waitcnt lgkmcnt(0)
s_barrier
s_cmp_ge_u32 s20, 4
s_cbranch_scc1 CV_g0_d
s_cmp_lg_u32 s33, 0
s_cbranch_scc1 CV_g0_0
buffer_load_dwordx3 v[48:50], v33, s[8:11], s31 offen offset:0
s_branch CV_g0_d
CV_g0_0:
s_cmp_lg_u32 s33, 1
s_cbranch_scc1 CV_g0_1
buffer_load_dwordx3 v[60:62], v33, s[8:11], s31 offen offset:3456
s_branch CV_g0_d
CV_g0_1:
buffer_load_dwordx3 v[72:74], v33, s[8:11], s35 offen offset:2304
CV_g0_d:
s_cmp_ge_u32 s20, 4
s_cbranch_scc1 CV_g1_d
s_cmp_lg_u32 s33, 0
s_cbranch_scc1 CV_g1_0
buffer_load_dwordx3 v[52:54], v33, s[8:11], s31 offen offset:1152
s_branch CV_g1_d
CV_g1_0:
s_cmp_lg_u32 s33, 1
s_cbranch_scc1 CV_g1_1
buffer_load_dwordx3 v[64:66], v33, s[8:11], s35 offen offset:0
s_branch CV_g1_d
CV_g1_1:
buffer_load_dwordx3 v[76:78], v33, s[8:11], s35 offen offset:3456
CV_g1_d:
s_cmp_ge_u32 s20, 4
s_cbranch_scc1 CV_g12
s_waitcnt vmcnt(2)
s_branch CV_kgen
CV_g12:
s_waitcnt vmcnt(0)
s_setprio 2
s_cmp_lt_u32 s20, 8
s_cbranch_scc1 CV_kgen
s_setprio 1
CV_kgen:
v_lshlrev_b32 v36, 16, v36
v_mul_f32 v36, 1069066811, v36
v_exp_f32 v36, v36
v_lshlrev_b32 v37, 16, v37
v_cvt_pk_bf16_f32 v36, v36, v36
v_readfirstlane_b32 s30, v37
v_lshlrev_b32 v36, 16, v36
v_lshlrev_b32 v80, 16, v40
v_lshlrev_b32 v81, 16, v41
v_lshlrev_b32 v82, 16, v42
v_lshlrev_b32 v83, 16, v43
v_lshlrev_b32 v84, 16, v44
v_lshlrev_b32 v85, 16, v45
v_lshlrev_b32 v86, 16, v46
v_lshlrev_b32 v87, 16, v47
v_lshlrev_b32 v35, 16, v38
v_lshlrev_b32 v37, 16, v39
v_mul_f32 v35, v36, v35
v_mul_f32 v37, v36, v37
v_mul_f32 v35, 1069066811, v35
v_pk_mul_f32 v[92:93], v[82:83], v[80:81] op_sel:[0,0] op_sel_hi:[0,1]
v_pk_fma_f32 v[88:89], v[82:83], v[80:81], v[92:93] op_sel:[1,1,0] op_sel_hi:[1,0,1] neg_lo:[1,0,0]
v_pk_mul_f32 v[92:93], v[86:87], v[84:85] op_sel:[0,0] op_sel_hi:[0,1]
v_pk_fma_f32 v[90:91], v[86:87], v[84:85], v[92:93] op_sel:[1,1,0] op_sel_hi:[1,0,1] neg_lo:[1,0,0]
v_max_f32 v10, |v88|, |v89|
v_max3_f32 v10, |v90|, |v91|, v10
v_mul_f32 v10, v36, v10
s_mov_b32 s54, 1042479491
s_mov_b32 s55, 836541576
v_max_u32_dpp v10, v10, v10 row_ror:1 row_mask:0xf bank_mask:0xf
s_nop 1
v_max_u32_dpp v10, v10, v10 row_ror:2 row_mask:0xf bank_mask:0xf
s_nop 1
v_max_u32_dpp v10, v10, v10 row_ror:4 row_mask:0xf bank_mask:0xf
s_nop 1
v_max_u32_dpp v10, v10, v10 row_ror:8 row_mask:0xf bank_mask:0xf
s_nop 0
v_readlane_b32 s52, v10, 0
v_readlane_b32 s53, v10, 16
v_readlane_b32 s68, v10, 32
v_readlane_b32 s69, v10, 48
s_max_u32 s52, s52, s53
s_max_u32 s68, s68, s69
s_max_u32 s52, s52, s68
s_lshr_b32 s52, s52, 23
s_add_u32 s52, s52, 8
s_bfe_u32 s53, s30, 0x80017
s_max_u32 s52, s52, s53
s_max_u32 s52, s52, 14
s_min_u32 s52, s52, 262
s_sub_u32 s53, 267, s52
s_lshl_b32 s53, s53, 23
v_exp_f32 v10, v35
v_mul_f32 v5, s54, v37
v_fma_f32 v83, v37, s54, -v5
v_fma_f32 v83, v37, s55, v83
v_fract_f32 v5, v5
v_add_f32 v5, v5, v83
v_cos_f32 v84, v5
v_sin_f32 v85, v5
v_mul_f32 v84, v84, v10
v_mul_f32 v85, v85, v10
v_mul_f32 v10, 1098907648, v35
v_mul_f32 v11, 1098907648, v37
v_exp_f32 v10, v10
v_mul_f32 v5, s54, v11
v_fma_f32 v83, v11, s54, -v5
v_fma_f32 v83, v11, s55, v83
v_fract_f32 v5, v5
v_add_f32 v5, v5, v83
v_cos_f32 v86, v5
v_sin_f32 v87, v5
v_mul_f32 v86, v86, v10
v_mul_f32 v87, v87, v10
v_mul_f32 v10, 1132462080, v35
v_mul_f32 v11, 1132462080, v37
v_exp_f32 v10, v10
v_mul_f32 v5, s54, v11
v_fma_f32 v83, v11, s54, -v5
v_fma_f32 v83, v11, s55, v83
v_fract_f32 v5, v5
v_add_f32 v5, v5, v83
v_cos_f32 v90, v5
v_sin_f32 v91, v5
v_mul_f32 v90, v90, v10
v_mul_f32 v91, v91, v10
v_mul_f32 v88, v36, v88
v_mul_f32 v89, v36, v89
v_mul_f32 v38, s53, v88
v_mul_f32 v39, s53, v89
s_cmp_ge_u32 s20, 4
s_cbranch_scc1 CV_g2_d
s_cmp_lg_u32 s33, 0
s_cbranch_scc1 CV_g2_0
buffer_load_dwordx3 v[56:58], v33, s[8:11], s31 offen offset:2304
s_branch CV_g2_d
CV_g2_0:
s_cmp_lg_u32 s33, 1
s_cbranch_scc1 CV_g2_1
buffer_load_dwordx3 v[68:70], v33, s[8:11], s35 offen offset:1152
s_branch CV_g2_d
CV_g2_1:
buffer_load_dwordx3 v[48:50], v33, s[8:11], s31 offen offset:0
CV_g2_d:
v_mov_b32 v83, 0x3c00
ds_write_addtid_b32 v83 offset:0
v_cvt_pk_f16_f32 v35, v86, v87
ds_write_addtid_b32 v35 offset:272
v_cvt_pk_f16_f32 v42, v38, -v39
ds_write_addtid_b32 v42 offset:52224
v_cvt_pk_f16_f32 v100, v90, -v91
v_pk_mul_f32 v[92:93], v[38:39], v[84:85] op_sel:[0,0] op_sel_hi:[0,1]
v_pk_fma_f32 v[40:41], v[38:39], v[84:85], v[92:93] op_sel:[1,1,0] op_sel_hi:[1,0,1] neg_lo:[1,0,0]
v_pk_mul_f32 v[108:109], v[86:87], v[86:87] op_sel:[0,0] op_sel_hi:[0,1]
v_pk_fma_f32 v[94:95], v[86:87], v[86:87], v[108:109] op_sel:[1,1,0] op_sel_hi:[1,0,1] neg_lo:[1,0,0]
v_pk_mul_f32 v[98:99], v[90:91], v[90:91] op_sel:[0,0] op_sel_hi:[0,1]
v_pk_fma_f32 v[98:99], v[90:91], v[90:91], v[98:99] op_sel:[1,1,0] op_sel_hi:[1,0,1] neg_lo:[1,0,0]
v_cvt_pk_f16_f32 v36, v40, -v41
ds_write_addtid_b32 v36 offset:52496
v_cvt_pk_f16_f32 v37, v94, v95
ds_write_addtid_b32 v37 offset:544
v_cvt_pk_f16_f32 v101, v98, -v99
s_cmp_ge_u32 s20, 4
s_cbranch_scc1 CV_g3_d
s_cmp_lg_u32 s33, 0
s_cbranch_scc1 CV_g3_0
buffer_load_dwordx3 v[60:62], v33, s[8:11], s31 offen offset:3456
s_branch CV_g3_d
CV_g3_0:
s_cmp_lg_u32 s33, 1
s_cbranch_scc1 CV_g3_1
buffer_load_dwordx3 v[72:74], v33, s[8:11], s35 offen offset:2304
s_branch CV_g3_d
CV_g3_1:
buffer_load_dwordx3 v[52:54], v33, s[8:11], s31 offen offset:1152
CV_g3_d:
v_pk_mul_f32 v[92:93], v[40:41], v[84:85] op_sel:[0,0] op_sel_hi:[0,1]
v_pk_fma_f32 v[38:39], v[40:41], v[84:85], v[92:93] op_sel:[1,1,0] op_sel_hi:[1,0,1] neg_lo:[1,0,0]
v_pk_mul_f32 v[108:109], v[94:95], v[86:87] op_sel:[0,0] op_sel_hi:[0,1]
v_pk_fma_f32 v[88:89], v[94:95], v[86:87], v[108:109] op_sel:[1,1,0] op_sel_hi:[1,0,1] neg_lo:[1,0,0]
v_pk_mul_f32 v[96:97], v[98:99], v[90:91] op_sel:[0,0] op_sel_hi:[0,1]
v_pk_fma_f32 v[96:97], v[98:99], v[90:91], v[96:97] op_sel:[1,1,0] op_sel_hi:[1,0,1] neg_lo:[1,0,0]
v_cvt_pk_f16_f32 v43, v38, -v39
ds_write_addtid_b32 v43 offset:52768
v_cvt_pk_f16_f32 v83, v88, v89
ds_write_addtid_b32 v83 offset:816
v_cvt_pk_f16_f32 v102, v96, -v97
v_pk_mul_f32 v[92:93], v[38:39], v[84:85] op_sel:[0,0] op_sel_hi:[0,1]
v_pk_fma_f32 v[40:41], v[38:39], v[84:85], v[92:93] op_sel:[1,1,0] op_sel_hi:[1,0,1] neg_lo:[1,0,0]
v_pk_mul_f32 v[108:109], v[88:89], v[86:87] op_sel:[0,0] op_sel_hi:[0,1]
v_pk_fma_f32 v[94:95], v[88:89], v[86:87], v[108:109] op_sel:[1,1,0] op_sel_hi:[1,0,1] neg_lo:[1,0,0]
v_pk_mul_f32 v[98:99], v[96:97], v[90:91] op_sel:[0,0] op_sel_hi:[0,1]
v_pk_fma_f32 v[98:99], v[96:97], v[90:91], v[98:99] op_sel:[1,1,0] op_sel_hi:[1,0,1] neg_lo:[1,0,0]
v_cvt_pk_f16_f32 v35, v40, -v41
ds_write_addtid_b32 v35 offset:53040
v_cvt_pk_f16_f32 v36, v94, v95
ds_write_addtid_b32 v36 offset:1088
v_cvt_pk_f16_f32 v103, v98, -v99
v_pk_mul_f32 v[92:93], v[40:41], v[84:85] op_sel:[0,0] op_sel_hi:[0,1]
v_pk_fma_f32 v[38:39], v[40:41], v[84:85], v[92:93] op_sel:[1,1,0] op_sel_hi:[1,0,1] neg_lo:[1,0,0]
v_pk_mul_f32 v[108:109], v[94:95], v[86:87] op_sel:[0,0] op_sel_hi:[0,1]
v_pk_fma_f32 v[88:89], v[94:95], v[86:87], v[108:109] op_sel:[1,1,0] op_sel_hi:[1,0,1] neg_lo:[1,0,0]
v_pk_mul_f32 v[96:97], v[98:99], v[90:91] op_sel:[0,0] op_sel_hi:[0,1]
v_pk_fma_f32 v[96:97], v[98:99], v[90:91], v[96:97] op_sel:[1,1,0] op_sel_hi:[1,0,1] neg_lo:[1,0,0]
v_cvt_pk_f16_f32 v44, v38, -v39
ds_write_addtid_b32 v44 offset:53312
v_cvt_pk_f16_f32 v37, v88, v89
ds_write_addtid_b32 v37 offset:1360
v_cvt_pk_f16_f32 v104, v96, -v97
v_pk_mul_f32 v[92:93], v[38:39], v[84:85] op_sel:[0,0] op_sel_hi:[0,1]
v_pk_fma_f32 v[40:41], v[38:39], v[84:85], v[92:93] op_sel:[1,1,0] op_sel_hi:[1,0,1] neg_lo:[1,0,0]
v_pk_mul_f32 v[108:109], v[88:89], v[86:87] op_sel:[0,0] op_sel_hi:[0,1]
v_pk_fma_f32 v[94:95], v[88:89], v[86:87], v[108:109] op_sel:[1,1,0] op_sel_hi:[1,0,1] neg_lo:[1,0,0]
v_pk_mul_f32 v[98:99], v[96:97], v[90:91] op_sel:[0,0] op_sel_hi:[0,1]
v_pk_fma_f32 v[98:99], v[96:97], v[90:91], v[98:99] op_sel:[1,1,0] op_sel_hi:[1,0,1] neg_lo:[1,0,0]
v_cvt_pk_f16_f32 v83, v40, -v41
ds_write_addtid_b32 v83 offset:53584
v_cvt_pk_f16_f32 v35, v94, v95
ds_write_addtid_b32 v35 offset:1632
v_cvt_pk_f16_f32 v105, v98, -v99
s_cmp_ge_u32 s20, 4
s_cbranch_scc1 CV_g4_d
s_cmp_lg_u32 s33, 0
s_cbranch_scc1 CV_g4_0
buffer_load_dwordx3 v[64:66], v33, s[8:11], s35 offen offset:0
s_branch CV_g4_d
CV_g4_0:
s_cmp_lg_u32 s33, 1
s_cbranch_scc1 CV_g4_1
buffer_load_dwordx3 v[76:78], v33, s[8:11], s35 offen offset:3456
s_branch CV_g4_d
CV_g4_1:
buffer_load_dwordx3 v[56:58], v33, s[8:11], s31 offen offset:2304
CV_g4_d:
v_pk_mul_f32 v[92:93], v[40:41], v[84:85] op_sel:[0,0] op_sel_hi:[0,1]
v_pk_fma_f32 v[38:39], v[40:41], v[84:85], v[92:93] op_sel:[1,1,0] op_sel_hi:[1,0,1] neg_lo:[1,0,0]
v_pk_mul_f32 v[108:109], v[94:95], v[86:87] op_sel:[0,0] op_sel_hi:[0,1]
v_pk_fma_f32 v[88:89], v[94:95], v[86:87], v[108:109] op_sel:[1,1,0] op_sel_hi:[1,0,1] neg_lo:[1,0,0]
v_pk_mul_f32 v[96:97], v[98:99], v[90:91] op_sel:[0,0] op_sel_hi:[0,1]
v_pk_fma_f32 v[96:97], v[98:99], v[90:91], v[96:97] op_sel:[1,1,0] op_sel_hi:[1,0,1] neg_lo:[1,0,0]
v_cvt_pk_f16_f32 v45, v38, -v39
ds_write_addtid_b32 v45 offset:53856
v_cvt_pk_f16_f32 v36, v88, v89
ds_write_addtid_b32 v36 offset:1904
v_cvt_pk_f16_f32 v106, v96, -v97
v_pk_mul_f32 v[92:93], v[38:39], v[84:85] op_sel:[0,0] op_sel_hi:[0,1]
v_pk_fma_f32 v[40:41], v[38:39], v[84:85], v[92:93] op_sel:[1,1,0] op_sel_hi:[1,0,1] neg_lo:[1,0,0]
v_pk_mul_f32 v[108:109], v[88:89], v[86:87] op_sel:[0,0] op_sel_hi:[0,1]
v_pk_fma_f32 v[94:95], v[88:89], v[86:87], v[108:109] op_sel:[1,1,0] op_sel_hi:[1,0,1] neg_lo:[1,0,0]
v_cvt_pk_f16_f32 v37, v40, -v41
ds_write_addtid_b32 v37 offset:54128
v_cvt_pk_f16_f32 v83, v94, v95
ds_write_addtid_b32 v83 offset:2176
v_pk_mul_f32 v[92:93], v[40:41], v[84:85] op_sel:[0,0] op_sel_hi:[0,1]
v_pk_fma_f32 v[38:39], v[40:41], v[84:85], v[92:93] op_sel:[1,1,0] op_sel_hi:[1,0,1] neg_lo:[1,0,0]
v_pk_mul_f32 v[108:109], v[94:95], v[86:87] op_sel:[0,0] op_sel_hi:[0,1]
v_pk_fma_f32 v[88:89], v[94:95], v[86:87], v[108:109] op_sel:[1,1,0] op_sel_hi:[1,0,1] neg_lo:[1,0,0]
v_cvt_pk_f16_f32 v46, v38, -v39
ds_write_addtid_b32 v46 offset:54400
v_cvt_pk_f16_f32 v35, v88, v89
ds_write_addtid_b32 v35 offset:2448
v_pk_mul_f32 v[92:93], v[38:39], v[84:85] op_sel:[0,0] op_sel_hi:[0,1]
v_pk_fma_f32 v[40:41], v[38:39], v[84:85], v[92:93] op_sel:[1,1,0] op_sel_hi:[1,0,1] neg_lo:[1,0,0]
v_pk_mul_f32 v[108:109], v[88:89], v[86:87] op_sel:[0,0] op_sel_hi:[0,1]
v_pk_fma_f32 v[94:95], v[88:89], v[86:87], v[108:109] op_sel:[1,1,0] op_sel_hi:[1,0,1] neg_lo:[1,0,0]
v_cvt_pk_f16_f32 v36, v40, -v41
ds_write_addtid_b32 v36 offset:54672
v_cvt_pk_f16_f32 v37, v94, v95
ds_write_addtid_b32 v37 offset:2720
s_cmp_ge_u32 s20, 4
s_cbranch_scc1 CV_g5_d
s_cmp_lg_u32 s33, 0
s_cbranch_scc1 CV_g5_0
buffer_load_dwordx3 v[68:70], v33, s[8:11], s35 offen offset:1152
s_branch CV_g5_d
CV_g5_0:
s_cmp_lg_u32 s33, 1
s_cbranch_scc1 CV_g5_1
buffer_load_dwordx3 v[48:50], v33, s[8:11], s31 offen offset:0
s_branch CV_g5_d
CV_g5_1:
buffer_load_dwordx3 v[60:62], v33, s[8:11], s31 offen offset:3456
CV_g5_d:
v_pk_mul_f32 v[92:93], v[40:41], v[84:85] op_sel:[0,0] op_sel_hi:[0,1]
v_pk_fma_f32 v[38:39], v[40:41], v[84:85], v[92:93] op_sel:[1,1,0] op_sel_hi:[1,0,1] neg_lo:[1,0,0]
v_pk_mul_f32 v[108:109], v[94:95], v[86:87] op_sel:[0,0] op_sel_hi:[0,1]
v_pk_fma_f32 v[88:89], v[94:95], v[86:87], v[108:109] op_sel:[1,1,0] op_sel_hi:[1,0,1] neg_lo:[1,0,0]
v_cvt_pk_f16_f32 v47, v38, -v39
ds_write_addtid_b32 v47 offset:54944
v_cvt_pk_f16_f32 v83, v88, v89
ds_write_addtid_b32 v83 offset:2992
v_pk_mul_f32 v[92:93], v[38:39], v[84:85] op_sel:[0,0] op_sel_hi:[0,1]
v_pk_fma_f32 v[40:41], v[38:39], v[84:85], v[92:93] op_sel:[1,1,0] op_sel_hi:[1,0,1] neg_lo:[1,0,0]
v_pk_mul_f32 v[108:109], v[88:89], v[86:87] op_sel:[0,0] op_sel_hi:[0,1]
v_pk_fma_f32 v[94:95], v[88:89], v[86:87], v[108:109] op_sel:[1,1,0] op_sel_hi:[1,0,1] neg_lo:[1,0,0]
v_cvt_pk_f16_f32 v35, v40, -v41
ds_write_addtid_b32 v35 offset:55216
v_cvt_pk_f16_f32 v36, v94, v95
ds_write_addtid_b32 v36 offset:3264
v_pk_mul_f32 v[92:93], v[40:41], v[84:85] op_sel:[0,0] op_sel_hi:[0,1]
v_pk_fma_f32 v[38:39], v[40:41], v[84:85], v[92:93] op_sel:[1,1,0] op_sel_hi:[1,0,1] neg_lo:[1,0,0]
v_pk_mul_f32 v[108:109], v[94:95], v[86:87] op_sel:[0,0] op_sel_hi:[0,1]
v_pk_fma_f32 v[88:89], v[94:95], v[86:87], v[108:109] op_sel:[1,1,0] op_sel_hi:[1,0,1] neg_lo:[1,0,0]
v_cvt_pk_f16_f32 v80, v38, -v39
ds_write_addtid_b32 v80 offset:55488
v_cvt_pk_f16_f32 v37, v88, v89
ds_write_addtid_b32 v37 offset:3536
v_pk_mul_f32 v[92:93], v[38:39], v[84:85] op_sel:[0,0] op_sel_hi:[0,1]
v_pk_fma_f32 v[40:41], v[38:39], v[84:85], v[92:93] op_sel:[1,1,0] op_sel_hi:[1,0,1] neg_lo:[1,0,0]
v_pk_mul_f32 v[108:109], v[88:89], v[86:87] op_sel:[0,0] op_sel_hi:[0,1]
v_pk_fma_f32 v[94:95], v[88:89], v[86:87], v[108:109] op_sel:[1,1,0] op_sel_hi:[1,0,1] neg_lo:[1,0,0]
v_cvt_pk_f16_f32 v83, v40, -v41
ds_write_addtid_b32 v83 offset:55760
v_cvt_pk_f16_f32 v35, v94, v95
ds_write_addtid_b32 v35 offset:3808
s_cmp_ge_u32 s20, 4
s_cbranch_scc1 CV_g6_d
s_cmp_lg_u32 s33, 0
s_cbranch_scc1 CV_g6_0
buffer_load_dwordx3 v[72:74], v33, s[8:11], s35 offen offset:2304
s_branch CV_g6_d
CV_g6_0:
s_cmp_lg_u32 s33, 1
s_cbranch_scc1 CV_g6_1
buffer_load_dwordx3 v[52:54], v33, s[8:11], s31 offen offset:1152
s_branch CV_g6_d
CV_g6_1:
buffer_load_dwordx3 v[64:66], v33, s[8:11], s35 offen offset:0
CV_g6_d:
v_pk_mul_f32 v[92:93], v[40:41], v[84:85] op_sel:[0,0] op_sel_hi:[0,1]
v_pk_fma_f32 v[38:39], v[40:41], v[84:85], v[92:93] op_sel:[1,1,0] op_sel_hi:[1,0,1] neg_lo:[1,0,0]
v_pk_mul_f32 v[108:109], v[94:95], v[86:87] op_sel:[0,0] op_sel_hi:[0,1]
v_pk_fma_f32 v[88:89], v[94:95], v[86:87], v[108:109] op_sel:[1,1,0] op_sel_hi:[1,0,1] neg_lo:[1,0,0]
v_cvt_pk_f16_f32 v81, v38, -v39
ds_write_addtid_b32 v81 offset:56032
v_cvt_pk_f16_f32 v36, v88, v89
ds_write_addtid_b32 v36 offset:4080
v_pk_mul_f32 v[92:93], v[38:39], v[84:85] op_sel:[0,0] op_sel_hi:[0,1]
v_pk_fma_f32 v[40:41], v[38:39], v[84:85], v[92:93] op_sel:[1,1,0] op_sel_hi:[1,0,1] neg_lo:[1,0,0]
v_cvt_pk_f16_f32 v37, v40, -v41
ds_write_addtid_b32 v37 offset:56304
v_pk_mul_f32 v[92:93], v[40:41], v[84:85] op_sel:[0,0] op_sel_hi:[0,1]
v_pk_fma_f32 v[38:39], v[40:41], v[84:85], v[92:93] op_sel:[1,1,0] op_sel_hi:[1,0,1] neg_lo:[1,0,0]
v_cvt_pk_f16_f32 v82, v38, -v39
ds_read_b128 v[108:111], v32 offset:0
ds_read_b128 v[112:115], v32 offset:64
ds_read_b128 v[116:119], v32 offset:128
ds_read_b128 v[120:123], v32 offset:192
ds_read_b128 v[124:127], v32 offset:52224
ds_read_b128 v[128:131], v32 offset:52288
ds_read_b128 v[132:135], v32 offset:52352
ds_read_b128 v[136:139], v32 offset:52416
v_pk_mul_f16 v83, v42, v100 op_sel:[0,0] op_sel_hi:[0,1]
v_pk_fma_f16 v83, v42, v100, v83 op_sel:[1,1,0] op_sel_hi:[1,0,1] neg_lo:[1,0,0]
ds_write_addtid_b32 v83 offset:0
v_pk_mul_f16 v35, v43, v100 op_sel:[0,0] op_sel_hi:[0,1]
v_pk_fma_f16 v35, v43, v100, v35 op_sel:[1,1,0] op_sel_hi:[1,0,1] neg_lo:[1,0,0]
ds_write_addtid_b32 v35 offset:272
v_pk_mul_f16 v36, v44, v100 op_sel:[0,0] op_sel_hi:[0,1]
v_pk_fma_f16 v36, v44, v100, v36 op_sel:[1,1,0] op_sel_hi:[1,0,1] neg_lo:[1,0,0]
ds_write_addtid_b32 v36 offset:544
v_pk_mul_f16 v37, v45, v100 op_sel:[0,0] op_sel_hi:[0,1]
v_pk_fma_f16 v37, v45, v100, v37 op_sel:[1,1,0] op_sel_hi:[1,0,1] neg_lo:[1,0,0]
ds_write_addtid_b32 v37 offset:816
v_pk_mul_f16 v83, v46, v100 op_sel:[0,0] op_sel_hi:[0,1]
v_pk_fma_f16 v83, v46, v100, v83 op_sel:[1,1,0] op_sel_hi:[1,0,1] neg_lo:[1,0,0]
ds_write_addtid_b32 v83 offset:1088
v_pk_mul_f16 v35, v47, v100 op_sel:[0,0] op_sel_hi:[0,1]
v_pk_fma_f16 v35, v47, v100, v35 op_sel:[1,1,0] op_sel_hi:[1,0,1] neg_lo:[1,0,0]
ds_write_addtid_b32 v35 offset:1360
v_pk_mul_f16 v36, v80, v100 op_sel:[0,0] op_sel_hi:[0,1]
v_pk_fma_f16 v36, v80, v100, v36 op_sel:[1,1,0] op_sel_hi:[1,0,1] neg_lo:[1,0,0]
ds_write_addtid_b32 v36 offset:1632
v_pk_mul_f16 v37, v81, v100 op_sel:[0,0] op_sel_hi:[0,1]
v_pk_fma_f16 v37, v81, v100, v37 op_sel:[1,1,0] op_sel_hi:[1,0,1] neg_lo:[1,0,0]
ds_write_addtid_b32 v37 offset:1904
v_pk_mul_f16 v83, v42, v101 op_sel:[0,0] op_sel_hi:[0,1]
v_pk_fma_f16 v83, v42, v101, v83 op_sel:[1,1,0] op_sel_hi:[1,0,1] neg_lo:[1,0,0]
ds_write_addtid_b32 v83 offset:2176
v_pk_mul_f16 v35, v42, v103 op_sel:[0,0] op_sel_hi:[0,1]
v_pk_fma_f16 v35, v42, v103, v35 op_sel:[1,1,0] op_sel_hi:[1,0,1] neg_lo:[1,0,0]
ds_write_addtid_b32 v35 offset:2448
s_cmp_ge_u32 s20, 4
s_cbranch_scc1 CV_g7_d
s_cmp_lg_u32 s33, 0
s_cbranch_scc1 CV_g7_0
buffer_load_dwordx3 v[76:78], v33, s[8:11], s35 offen offset:3456
s_branch CV_g7_d
CV_g7_0:
s_cmp_lg_u32 s33, 1
s_cbranch_scc1 CV_g7_1
buffer_load_dwordx3 v[56:58], v33, s[8:11], s31 offen offset:2304
s_branch CV_g7_d
CV_g7_1:
buffer_load_dwordx3 v[68:70], v33, s[8:11], s35 offen offset:1152
CV_g7_d:
s_waitcnt lgkmcnt(13)
v_mfma_f32_16x16x32_f16 v[140:143], v[124:127], v[108:111], 0
s_waitcnt lgkmcnt(12)
v_mfma_f32_16x16x32_f16 v[140:143], v[128:131], v[112:115], v[140:143]
s_waitcnt lgkmcnt(11)
v_mfma_f32_16x16x32_f16 v[140:143], v[132:135], v[116:119], v[140:143]
s_waitcnt lgkmcnt(10)
v_mfma_f32_16x16x32_f16 v[140:143], v[136:139], v[120:123], v[140:143]
ds_read_b128 v[124:127], v32 offset:0
ds_read_b128 v[128:131], v32 offset:64
ds_read_b128 v[132:135], v32 offset:128
ds_read_b128 v[136:139], v32 offset:192
v_pk_mul_f16 v36, v44, v101 op_sel:[0,0] op_sel_hi:[0,1]
v_pk_fma_f16 v36, v44, v101, v36 op_sel:[1,1,0] op_sel_hi:[1,0,1] neg_lo:[1,0,0]
ds_write_addtid_b32 v36 offset:52224
v_pk_mul_f16 v37, v46, v101 op_sel:[0,0] op_sel_hi:[0,1]
v_pk_fma_f16 v37, v46, v101, v37 op_sel:[1,1,0] op_sel_hi:[1,0,1] neg_lo:[1,0,0]
ds_write_addtid_b32 v37 offset:52496
v_pk_mul_f16 v83, v80, v101 op_sel:[0,0] op_sel_hi:[0,1]
v_pk_fma_f16 v83, v80, v101, v83 op_sel:[1,1,0] op_sel_hi:[1,0,1] neg_lo:[1,0,0]
ds_write_addtid_b32 v83 offset:52768
v_pk_mul_f16 v35, v82, v101 op_sel:[0,0] op_sel_hi:[0,1]
v_pk_fma_f16 v35, v82, v101, v35 op_sel:[1,1,0] op_sel_hi:[1,0,1] neg_lo:[1,0,0]
ds_write_addtid_b32 v35 offset:53040
v_pk_mul_f16 v36, v44, v102 op_sel:[0,0] op_sel_hi:[0,1]
v_pk_fma_f16 v36, v44, v102, v36 op_sel:[1,1,0] op_sel_hi:[1,0,1] neg_lo:[1,0,0]
ds_write_addtid_b32 v36 offset:53312
v_pk_mul_f16 v37, v46, v102 op_sel:[0,0] op_sel_hi:[0,1]
v_pk_fma_f16 v37, v46, v102, v37 op_sel:[1,1,0] op_sel_hi:[1,0,1] neg_lo:[1,0,0]
ds_write_addtid_b32 v37 offset:53584
v_pk_mul_f16 v83, v80, v102 op_sel:[0,0] op_sel_hi:[0,1]
v_pk_fma_f16 v83, v80, v102, v83 op_sel:[1,1,0] op_sel_hi:[1,0,1] neg_lo:[1,0,0]
ds_write_addtid_b32 v83 offset:53856
v_pk_mul_f16 v35, v82, v102 op_sel:[0,0] op_sel_hi:[0,1]
v_pk_fma_f16 v35, v82, v102, v35 op_sel:[1,1,0] op_sel_hi:[1,0,1] neg_lo:[1,0,0]
ds_write_addtid_b32 v35 offset:54128
s_waitcnt lgkmcnt(11)
v_mfma_f32_16x16x32_f16 v[144:147], v[124:127], v[108:111], 0
s_waitcnt lgkmcnt(10)
v_mfma_f32_16x16x32_f16 v[144:147], v[128:131], v[112:115], v[144:147]
s_waitcnt lgkmcnt(9)
v_mfma_f32_16x16x32_f16 v[144:147], v[132:135], v[116:119], v[144:147]
s_waitcnt lgkmcnt(8)
v_mfma_f32_16x16x32_f16 v[144:147], v[136:139], v[120:123], v[144:147]
v_pk_mul_f16 v36, v46, v103 op_sel:[0,0] op_sel_hi:[0,1]
v_pk_fma_f16 v36, v46, v103, v36 op_sel:[1,1,0] op_sel_hi:[1,0,1] neg_lo:[1,0,0]
ds_write_addtid_b32 v36 offset:54400
v_pk_mul_f16 v37, v82, v103 op_sel:[0,0] op_sel_hi:[0,1]
v_pk_fma_f16 v37, v82, v103, v37 op_sel:[1,1,0] op_sel_hi:[1,0,1] neg_lo:[1,0,0]
ds_write_addtid_b32 v37 offset:54672
v_pk_mul_f16 v83, v46, v104 op_sel:[0,0] op_sel_hi:[0,1]
v_pk_fma_f16 v83, v46, v104, v83 op_sel:[1,1,0] op_sel_hi:[1,0,1] neg_lo:[1,0,0]
ds_write_addtid_b32 v83 offset:54944
v_pk_mul_f16 v35, v82, v104 op_sel:[0,0] op_sel_hi:[0,1]
v_pk_fma_f16 v35, v82, v104, v35 op_sel:[1,1,0] op_sel_hi:[1,0,1] neg_lo:[1,0,0]
ds_write_addtid_b32 v35 offset:55216
v_pk_mul_f16 v36, v46, v105 op_sel:[0,0] op_sel_hi:[0,1]
v_pk_fma_f16 v36, v46, v105, v36 op_sel:[1,1,0] op_sel_hi:[1,0,1] neg_lo:[1,0,0]
ds_write_addtid_b32 v36 offset:55488
v_pk_mul_f16 v37, v82, v105 op_sel:[0,0] op_sel_hi:[0,1]
v_pk_fma_f16 v37, v82, v105, v37 op_sel:[1,1,0] op_sel_hi:[1,0,1] neg_lo:[1,0,0]
ds_write_addtid_b32 v37 offset:55760
v_pk_mul_f16 v83, v46, v106 op_sel:[0,0] op_sel_hi:[0,1]
v_pk_fma_f16 v83, v46, v106, v83 op_sel:[1,1,0] op_sel_hi:[1,0,1] neg_lo:[1,0,0]
ds_write_addtid_b32 v83 offset:56032
v_pk_mul_f16 v35, v82, v106 op_sel:[0,0] op_sel_hi:[0,1]
v_pk_fma_f16 v35, v82, v106, v35 op_sel:[1,1,0] op_sel_hi:[1,0,1] neg_lo:[1,0,0]
ds_write_addtid_b32 v35 offset:56304
ds_read_b128 v[124:127], v32 offset:52224
ds_read_b128 v[128:131], v32 offset:52288
ds_read_b128 v[132:135], v32 offset:52352
ds_read_b128 v[136:139], v32 offset:52416
v_mov_b32 v38, 0
v_mov_b32 v39, 0
v_mov_b32 v40, 0
v_mov_b32 v41, 0
ds_write_b128 v12, v[38:41] offset:52224
ds_write_b128 v12, v[38:41] offset:53248
ds_write_b128 v12, v[38:41] offset:54272
ds_write_b128 v12, v[38:41] offset:55296
ds_write_addtid_b32 v38 offset:56320
ds_write_b128 v12, v[140:143]
ds_write_b128 v12, v[144:147] offset:1024
s_waitcnt lgkmcnt(10)
v_mfma_f32_16x16x32_f16 v[148:151], v[108:111], v[124:127], 0
s_waitcnt lgkmcnt(9)
v_mfma_f32_16x16x32_f16 v[148:151], v[112:115], v[128:131], v[148:151]
s_waitcnt lgkmcnt(8)
v_mfma_f32_16x16x32_f16 v[148:151], v[116:119], v[132:135], v[148:151]
s_waitcnt lgkmcnt(7)
v_mfma_f32_16x16x32_f16 v[148:151], v[120:123], v[136:139], v[148:151]
ds_read_b32 v84, v17 offset:256
ds_read_b32 v85, v17 offset:512
ds_read_b32 v86, v17 offset:768
ds_read_b32 v87, v17 offset:1024
ds_read_b32 v88, v17 offset:1280
ds_read_b32 v89, v17 offset:1536
ds_read_b32 v90, v17 offset:1792
s_lshl_b64 s[66:67], 1, s57
s_sub_u32 s63, s60, s62
s_add_u32 s63, s63, 126
s_sub_u32 s65, s64, s62
s_sub_u32 s65, s65, 384
s_lshl_b32 s58, s23, 10
v_add_u32 v5, s58, v13
ds_write_b128 v12, v[148:151] offset:2048
ds_write_b32 v16, v19 offset:0
s_waitcnt lgkmcnt(8)
v_add_u32 v6, s63, v84
v_add_u32 v7, 640, v6
s_waitcnt lgkmcnt(7)
v_add_u32 v14, s65, v85
s_lshl_b32 s65, s23, 9
s_add_u32 s65, s65, 1032
s_waitcnt lgkmcnt(6)
v_add_u32 v41, s65, v86
s_mul_i32 s65, s23, 288
s_add_u32 s65, s65, s61
s_waitcnt lgkmcnt(5)
v_add_u32 v8, s65, v87
s_mul_i32 s65, s23, 176
s_add_u32 s65, s65, s61
v_add_u32 v9, s65, v87
v_lshlrev_b32 v1, 5, v3
v_lshl_add_u32 v15, v4, 4, v1
s_lshl_b32 s65, s23, 4
s_sub_u32 s65, s64, s65
s_sub_u32 s65, s65, 32
v_add_u32 v15, s65, v15
v_lshl_add_u32 v1, v4, 3, v1
ds_read2_b32 v[20:21], v86 offset0:0 offset1:1
ds_read2_b32 v[22:23], v86 offset0:2 offset1:3
ds_read2_b32 v[24:25], v86 offset0:130 offset1:131
ds_read2_b32 v[26:27], v86 offset0:132 offset1:133
ds_read2_b32 v[28:29], v41 offset0:0 offset1:1
ds_read2_b32 v[30:31], v41 offset0:2 offset1:3
CV_poll0:
ds_read_b32 v18, v17
s_waitcnt lgkmcnt(0)
v_cmp_eq_u32 vcc, 0, v18
s_nop 1
s_and_b64 vcc, vcc, s[66:67]
s_cbranch_scc0 CV_poll0_ok
s_sleep 2
s_branch CV_poll0
CV_poll0_ok:
ds_read_b128 v[94:97], v5
ds_read_b128 v[98:101], v5 offset:1024
s_cmp_eq_u32 s23, 1
s_cbranch_scc1 CV_kfin1
v_sub_u32 v38, s60, v1
v_mov_b32 v11, s30
v_mul_f32 v11, s53, v11
v_cmp_eq_u32 vcc, 0, v2
s_nop 1
v_cndmask_b32 v11, 0, v11, vcc
v_add_f32 v140, v140, v11
s_waitcnt lgkmcnt(1)
v_pk_add_f32 v[140:141], v[140:141], v[94:95]
v_pk_add_f32 v[142:143], v[142:143], v[96:97]
v_cvt_pk_f16_f32 v102, v143, v142
v_cvt_pk_f16_f32 v103, v141, v140
v_cvt_pk_f16_f32 v104, v142, v141
ds_write_b64 v38, v[102:103] offset:1272
ds_write_b16 v38, v102 offset:2618
ds_write_b32 v38, v104 offset:2620
ds_write_b16_d16_hi v38, v103 offset:2624
s_branch CV_kfin_done
CV_kfin1:
v_sub_u32 v39, s60, v89
v_add_u32 v40, s61, v90
v_cmp_eq_u32 s[68:69], 32, v2
s_waitcnt lgkmcnt(1)
v_pk_add_f32 v[144:145], v[144:145], v[94:95]
v_pk_add_f32 v[146:147], v[146:147], v[96:97]
s_waitcnt lgkmcnt(0)
v_pk_add_f32 v[148:149], v[148:149], v[98:99]
v_pk_add_f32 v[150:151], v[150:151], v[100:101]
ds_bpermute_b32 v94, v88, v144
v_cvt_pk_f16_f32 v102, v151, v150
v_cvt_pk_f16_f32 v103, v149, v148
v_cvt_pk_f16_f32 v104, v150, v149
ds_write_b64 v40, v[102:103]
ds_write_b16 v40, v102 offset:930
ds_write_b32 v40, v104 offset:932
ds_write_b16_d16_hi v40, v103 offset:936
ds_write_b32 v40, v102 offset:1860
ds_write_b32 v40, v103 offset:1864
ds_write_b16 v40, v102 offset:2790
ds_write_b32 v40, v104 offset:2792
ds_write_b16_d16_hi v40, v103 offset:2796
v_cvt_pk_f16_f32 v109, v145, v145
v_cndmask_b32 v145, v145, v144, s[68:69]
v_cndmask_b32 v146, v146, 0, s[68:69]
v_cndmask_b32 v147, v147, 0, s[68:69]
s_waitcnt lgkmcnt(9)
v_cndmask_b32 v94, v94, 0, s[68:69]
v_cvt_pk_f16_f32 v148, v94, v147
v_cvt_pk_f16_f32 v149, v146, v146
v_cvt_pk_f16_f32 v150, v146, v145
v_cvt_pk_f16_f32 v151, v144, v144
v_mov_b32 v106, v149
v_cvt_pk_f16_f32 v107, v145, v144
v_cvt_pk_f16_f32 v108, v147, v146
v_mov_b32 v5, s60
s_mov_b32 exec_hi, 1
ds_write_b128 v39, v[148:151] offset:752
ds_write_b16 v39, v148 offset:2098
ds_write_b32 v39, v108 offset:2100
ds_write_b64 v39, v[106:107] offset:2104
ds_write_b16 v39, v151 offset:2112
s_mov_b32 exec_lo, 0
ds_write_b16 v5, v109 offset:118
ds_write_b16 v5, v109 offset:120
ds_write_b32 v5, v109 offset:1464
s_mov_b64 exec, -1
CV_kfin_done:
ds_write_b32 v16, v19 offset:48
s_lshl_b64 s[66:67], s[66:67], 12
s_cmp_ge_u32 s20, 4
s_cbranch_scc1 CV_nox
s_mov_b32 s58, 0x7fff7fff
s_mov_b32 s70, 0
s_mov_b32 s71, 0xf0
s_waitcnt vmcnt(0)
v_max_f32 v36, |v48|, |v52|
v_max3_f32 v36, |v56|, |v60|, v36
v_max3_f32 v36, |v64|, |v68|, v36
v_max3_f32 v36, |v72|, |v76|, v36
v_max3_f32 v36, |v49|, |v53|, v36
v_max3_f32 v36, |v57|, |v61|, v36
v_max3_f32 v36, |v65|, |v69|, v36
v_max3_f32 v36, |v73|, |v77|, v36
v_max3_f32 v36, |v50|, |v54|, v36
v_max3_f32 v36, |v58|, |v62|, v36
v_max3_f32 v36, |v66|, |v70|, v36
v_max3_f32 v36, |v74|, |v78|, v36
v_lshlrev_b32 v80, 16, v48
v_lshlrev_b32 v81, 16, v52
v_lshlrev_b32 v82, 16, v56
v_lshlrev_b32 v83, 16, v60
v_lshlrev_b32 v84, 16, v64
v_lshlrev_b32 v85, 16, v68
v_lshlrev_b32 v86, 16, v72
v_lshlrev_b32 v87, 16, v76
v_lshlrev_b32 v88, 16, v49
v_lshlrev_b32 v89, 16, v53
v_lshlrev_b32 v90, 16, v57
v_lshlrev_b32 v91, 16, v61
v_lshlrev_b32 v92, 16, v65
v_lshlrev_b32 v93, 16, v69
v_lshlrev_b32 v94, 16, v73
v_lshlrev_b32 v95, 16, v77
v_lshlrev_b32 v96, 16, v50
v_lshlrev_b32 v97, 16, v54
v_lshlrev_b32 v98, 16, v58
v_lshlrev_b32 v99, 16, v62
v_lshlrev_b32 v100, 16, v66
v_lshlrev_b32 v101, 16, v70
v_lshlrev_b32 v102, 16, v74
v_lshlrev_b32 v103, 16, v78
v_max_f32 v37, |v80|, |v81|
v_max3_f32 v37, |v82|, |v83|, v37
v_max3_f32 v37, |v84|, |v85|, v37
v_max3_f32 v37, |v86|, |v87|, v37
v_max3_f32 v37, |v88|, |v89|, v37
v_max3_f32 v37, |v90|, |v91|, v37
v_max3_f32 v37, |v92|, |v93|, v37
v_max3_f32 v37, |v94|, |v95|, v37
v_max3_f32 v37, |v96|, |v97|, v37
v_max3_f32 v37, |v98|, |v99|, v37
v_max3_f32 v37, |v100|, |v101|, v37
v_max3_f32 v37, |v102|, |v103|, v37
v_max_u32 v36, v36, v37
s_nop 1
v_max_u32_dpp v36, v36, v36 row_ror:1 row_mask:0xf bank_mask:0xf
s_nop 1
v_max_u32_dpp v36, v36, v36 row_ror:2 row_mask:0xf bank_mask:0xf
s_nop 1
v_max_u32_dpp v36, v36, v36 row_ror:4 row_mask:0xf bank_mask:0xf
s_nop 1
v_max_u32_dpp v36, v36, v36 row_ror:8 row_mask:0xf bank_mask:0xf
s_nop 0
v_readlane_b32 s58, v36, 0
v_readlane_b32 s59, v36, 16
v_readlane_b32 s68, v36, 32
v_readlane_b32 s69, v36, 48
s_max_u32 s58, s58, s59
s_max_u32 s68, s68, s69
s_max_u32 s58, s58, s68
s_or_b32 s58, s58, 1
v_mov_b32 v36, s58
ds_write_b32 v16, v36 offset:144
s_nop 0
CV_poll1:
ds_read_b32 v18, v17
s_waitcnt lgkmcnt(0)
v_cmp_eq_u32 vcc, 0, v18
s_nop 1
s_and_b64 vcc, vcc, s[70:71]
s_cbranch_scc0 CV_poll1_ok
s_sleep 2
s_branch CV_poll1
CV_poll1_ok:
v_readlane_b32 s58, v18, 36
v_readlane_b32 s59, v18, 37
v_readlane_b32 s68, v18, 38
v_readlane_b32 s69, v18, 39
s_max_u32 s58, s58, s59
s_max_u32 s68, s68, s69
s_max_u32 s59, s58, s68
s_lshr_b32 s59, s59, 23
s_max_u32 s59, s59, 11
s_min_u32 s59, s59, 254
s_sub_u32 s58, 264, s59
s_lshl_b32 s58, s58, 23
v_fma_mixlo_f16 v104, v80, s58, 0
v_fma_mixlo_f16 v105, v82, s58, 0
v_fma_mixlo_f16 v106, v84, s58, 0
v_fma_mixlo_f16 v107, v86, s58, 0
v_fma_mixhi_f16 v104, v81, s58, 0
v_fma_mixhi_f16 v105, v83, s58, 0
v_fma_mixhi_f16 v106, v85, s58, 0
v_fma_mixhi_f16 v107, v87, s58, 0
ds_write_b128 v34, v[104:107] offset:0
v_and_b32 v36, 0xffff0000, v48
v_and_b32 v37, 0xffff0000, v52
v_and_b32 v38, 0xffff0000, v56
v_and_b32 v39, 0xffff0000, v60
v_and_b32 v40, 0xffff0000, v64
v_and_b32 v41, 0xffff0000, v68
v_and_b32 v42, 0xffff0000, v72
v_and_b32 v43, 0xffff0000, v76
v_fma_mixlo_f16 v108, v36, s58, 0
v_fma_mixlo_f16 v109, v38, s58, 0
v_fma_mixlo_f16 v110, v40, s58, 0
v_fma_mixlo_f16 v111, v42, s58, 0
v_fma_mixhi_f16 v108, v37, s58, 0
v_fma_mixhi_f16 v109, v39, s58, 0
v_fma_mixhi_f16 v110, v41, s58, 0
v_fma_mixhi_f16 v111, v43, s58, 0
ds_write_b128 v34, v[108:111] offset:4608
v_fma_mixlo_f16 v104, v88, s58, 0
v_fma_mixlo_f16 v105, v90, s58, 0
v_fma_mixlo_f16 v106, v92, s58, 0
v_fma_mixlo_f16 v107, v94, s58, 0
v_fma_mixhi_f16 v104, v89, s58, 0
v_fma_mixhi_f16 v105, v91, s58, 0
v_fma_mixhi_f16 v106, v93, s58, 0
v_fma_mixhi_f16 v107, v95, s58, 0
ds_write_b128 v34, v[104:107] offset:9216
v_and_b32 v36, 0xffff0000, v49
v_and_b32 v37, 0xffff0000, v53
v_and_b32 v38, 0xffff0000, v57
v_and_b32 v39, 0xffff0000, v61
v_and_b32 v40, 0xffff0000, v65
v_and_b32 v41, 0xffff0000, v69
v_and_b32 v42, 0xffff0000, v73
v_and_b32 v43, 0xffff0000, v77
v_fma_mixlo_f16 v108, v36, s58, 0
v_fma_mixlo_f16 v109, v38, s58, 0
v_fma_mixlo_f16 v110, v40, s58, 0
v_fma_mixlo_f16 v111, v42, s58, 0
v_fma_mixhi_f16 v108, v37, s58, 0
v_fma_mixhi_f16 v109, v39, s58, 0
v_fma_mixhi_f16 v110, v41, s58, 0
v_fma_mixhi_f16 v111, v43, s58, 0
ds_write_b128 v34, v[108:111] offset:13824
v_fma_mixlo_f16 v104, v96, s58, 0
v_fma_mixlo_f16 v105, v98, s58, 0
v_fma_mixlo_f16 v106, v100, s58, 0
v_fma_mixlo_f16 v107, v102, s58, 0
v_fma_mixhi_f16 v104, v97, s58, 0
v_fma_mixhi_f16 v105, v99, s58, 0
v_fma_mixhi_f16 v106, v101, s58, 0
v_fma_mixhi_f16 v107, v103, s58, 0
ds_write_b128 v34, v[104:107] offset:18432
v_and_b32 v36, 0xffff0000, v50
v_and_b32 v37, 0xffff0000, v54
v_and_b32 v38, 0xffff0000, v58
v_and_b32 v39, 0xffff0000, v62
v_and_b32 v40, 0xffff0000, v66
v_and_b32 v41, 0xffff0000, v70
v_and_b32 v42, 0xffff0000, v74
v_and_b32 v43, 0xffff0000, v78
v_fma_mixlo_f16 v108, v36, s58, 0
v_fma_mixlo_f16 v109, v38, s58, 0
v_fma_mixlo_f16 v110, v40, s58, 0
v_fma_mixlo_f16 v111, v42, s58, 0
v_fma_mixhi_f16 v108, v37, s58, 0
v_fma_mixhi_f16 v109, v39, s58, 0
v_fma_mixhi_f16 v110, v41, s58, 0
v_fma_mixhi_f16 v111, v43, s58, 0
ds_write_b128 v34, v[108:111] offset:23040
ds_write_b32 v16, v19 offset:160
CV_nox:
CV_poll2:
ds_read_b32 v18, v17
s_waitcnt lgkmcnt(0)
v_cmp_eq_u32 vcc, 0, v18
s_nop 1
s_and_b64 vcc, vcc, s[66:67]
s_cbranch_scc0 CV_poll2_ok
s_sleep 2
s_branch CV_poll2
CV_poll2_ok:
ds_read2_b32 v[32:33], v7 offset0:128 offset1:129
ds_read2_b32 v[34:35], v7 offset0:130 offset1:131
ds_read2_b32 v[36:37], v7 offset0:96 offset1:97
ds_read2_b32 v[38:39], v7 offset0:98 offset1:99
ds_read2_b32 v[40:41], v7 offset0:64 offset1:65
ds_read2_b32 v[42:43], v7 offset0:66 offset1:67
ds_read2_b32 v[44:45], v7 offset0:32 offset1:33
ds_read2_b32 v[46:47], v7 offset0:34 offset1:35
ds_read2_b32 v[48:49], v7 offset0:0 offset1:1
ds_read2_b32 v[50:51], v7 offset0:2 offset1:3
ds_read2_b32 v[52:53], v6 offset0:128 offset1:129
ds_read2_b32 v[54:55], v6 offset0:130 offset1:131
ds_read2_b32 v[56:57], v6 offset0:96 offset1:97
ds_read2_b32 v[58:59], v6 offset0:98 offset1:99
ds_read2_b32 v[60:61], v6 offset0:64 offset1:65
ds_read2_b32 v[62:63], v6 offset0:66 offset1:67
ds_read2_b32 v[64:65], v6 offset0:32 offset1:33
ds_read2_b32 v[66:67], v6 offset0:34 offset1:35
ds_read2_b32 v[68:69], v6 offset0:0 offset1:1
ds_read2_b32 v[70:71], v6 offset0:2 offset1:3
ds_read_b64 v[72:73], v8 offset:94
ds_read_b64 v[74:75], v8 offset:238
ds_read_b64 v[76:77], v8 offset:62
ds_read_b64 v[78:79], v8 offset:206
ds_read_b64 v[80:81], v8 offset:30
ds_read_b64 v[82:83], v8 offset:174
ds_read_b64 v[84:85], v9 offset:606
ds_read_b64 v[86:87], v9 offset:638
ds_read_b64 v[88:89], v9 offset:670
ds_read_b64 v[90:91], v9 offset:702
v_mov_b32 v92, 0
v_mov_b32 v93, 0
s_mov_b32 s66, 4095
s_mov_b32 s67, 0xf00
CV_poll3:
ds_read_b32 v18, v17
s_waitcnt lgkmcnt(0)
v_cmp_eq_u32 vcc, 0, v18
s_nop 1
s_and_b64 vcc, vcc, s[66:67]
s_cbranch_scc0 CV_poll3_ok
s_sleep 2
s_branch CV_poll3
CV_poll3_ok:
ds_read_b128 v[142:145], v15
ds_read_b128 v[126:129], v14 offset:0
ds_read_b128 v[130:133], v14 offset:128
ds_read_b128 v[134:137], v14 offset:256
ds_read_b128 v[138:141], v14 offset:384
ds_read_b128 v[6:9], v14 offset:512
v_readlane_b32 s58, v18, 36
v_readlane_b32 s59, v18, 37
v_readlane_b32 s68, v18, 38
v_readlane_b32 s69, v18, 39
s_max_u32 s58, s58, s59
s_max_u32 s68, s68, s69
s_max_u32 s59, s58, s68
s_lshr_b32 s59, s59, 23
s_max_u32 s59, s59, 11
s_min_u32 s59, s59, 254
s_add_u32 s59, s59, s52
s_sub_u32 s59, s59, 277
s_lshl_b64 s[66:67], 1, s57
s_lshl_b64 s[66:67], s[66:67], 24
s_cmp_eq_u32 s23, 1
s_waitcnt lgkmcnt(5)
v_mfma_f32_16x16x32_f16 v[146:149], v[142:145], v[20:23], 0
v_mfma_f32_16x16x32_f16 v[150:153], v[142:145], v[24:27], 0
v_mfma_f32_16x16x32_f16 v[154:157], v[142:145], v[28:31], 0
ds_read_b128 v[142:145], v15 offset:512
ds_read_b128 v[2:5], v14 offset:640
s_waitcnt lgkmcnt(6)
v_mfma_f32_16x16x32_f16 v[94:97], v[44:47], v[126:129], 0
v_mfma_f32_16x16x32_f16 v[98:101], v[60:63], v[126:129], 0
ds_read_b128 v[126:129], v14 offset:768
s_waitcnt lgkmcnt(6)
v_mfma_f32_16x16x32_f16 v[94:97], v[40:43], v[130:133], v[94:97]
v_mfma_f32_16x16x32_f16 v[98:101], v[56:59], v[130:133], v[98:101]
ds_read_b128 v[130:133], v14 offset:896
s_waitcnt lgkmcnt(6)
v_mfma_f32_16x16x32_f16 v[94:97], v[36:39], v[134:137], v[94:97]
v_cvt_pk_f16_f32 v158, v146, v147
v_mfma_f32_16x16x32_f16 v[98:101], v[52:55], v[134:137], v[98:101]
v_cvt_pk_f16_f32 v159, v148, v149
ds_read_b128 v[134:137], v14 offset:1024
s_waitcnt lgkmcnt(6)
v_mfma_f32_16x16x32_f16 v[94:97], v[32:35], v[138:141], v[94:97]
v_cvt_pk_f16_f32 v160, v150, v151
v_mfma_f32_16x16x32_f16 v[98:101], v[48:51], v[138:141], v[98:101]
v_cvt_pk_f16_f32 v161, v152, v153
v_mfma_f32_16x16x32_f16 v[102:105], v[64:67], v[138:141], 0
v_cvt_pk_f16_f32 v162, v154, v155
v_mfma_f32_16x16x32_f16 v[110:113], v[68:71], v[138:141], 0
v_cvt_pk_f16_f32 v163, v156, v157
ds_read_b128 v[138:141], v14 offset:1152
s_waitcnt lgkmcnt(6)
v_mfma_f32_16x16x32_f16 v[98:101], v[44:47], v[6:9], v[98:101]
v_mfma_f32_16x16x32_f16 v[102:105], v[60:63], v[6:9], v[102:105]
v_mfma_f32_16x16x32_f16 v[102:105], v[158:161], v[72:75], v[102:105]
v_mfma_f32_16x16x32_f16 v[106:109], v[158:161], v[76:79], 0
v_mfma_f32_16x16x32_f16 v[110:113], v[158:161], v[80:83], v[110:113]
s_waitcnt lgkmcnt(5)
v_mfma_f32_16x16x32_f16 v[146:149], v[142:145], v[20:23], 0
v_mfma_f32_16x16x32_f16 v[150:153], v[142:145], v[24:27], 0
v_mfma_f32_16x16x32_f16 v[154:157], v[142:145], v[28:31], 0
ds_read_b128 v[142:145], v15 offset:1024
ds_read_b128 v[6:9], v14 offset:1280
s_waitcnt lgkmcnt(6)
v_mfma_f32_16x16x32_f16 v[98:101], v[40:43], v[2:5], v[98:101]
v_mfma_f32_16x16x32_f16 v[102:105], v[56:59], v[2:5], v[102:105]
ds_read_b128 v[2:5], v14 offset:1408
s_waitcnt lgkmcnt(6)
v_mfma_f32_16x16x32_f16 v[98:101], v[36:39], v[126:129], v[98:101]
v_mfma_f32_16x16x32_f16 v[102:105], v[52:55], v[126:129], v[102:105]
ds_read_b128 v[126:129], v14 offset:1536
s_waitcnt lgkmcnt(6)
v_mfma_f32_16x16x32_f16 v[98:101], v[32:35], v[130:133], v[98:101]
v_cvt_pk_f16_f32 v158, v146, v147
v_mfma_f32_16x16x32_f16 v[102:105], v[48:51], v[130:133], v[102:105]
v_cvt_pk_f16_f32 v159, v148, v149
v_mfma_f32_16x16x32_f16 v[106:109], v[64:67], v[130:133], v[106:109]
v_cvt_pk_f16_f32 v160, v150, v151
v_mfma_f32_16x16x32_f16 v[114:117], v[68:71], v[130:133], 0
v_cvt_pk_f16_f32 v161, v152, v153
ds_read_b128 v[130:133], v14 offset:1664
s_waitcnt lgkmcnt(6)
v_mfma_f32_16x16x32_f16 v[102:105], v[44:47], v[134:137], v[102:105]
v_cvt_pk_f16_f32 v164, v154, v155
v_mfma_f32_16x16x32_f16 v[106:109], v[60:63], v[134:137], v[106:109]
v_cvt_pk_f16_f32 v165, v156, v157
ds_read_b128 v[134:137], v14 offset:1792
s_waitcnt lgkmcnt(6)
v_mfma_f32_16x16x32_f16 v[102:105], v[40:43], v[138:141], v[102:105]
v_mfma_f32_16x16x32_f16 v[106:109], v[56:59], v[138:141], v[106:109]
v_mfma_f32_16x16x32_f16 v[106:109], v[158:161], v[72:75], v[106:109]
v_mfma_f32_16x16x32_f16 v[110:113], v[158:161], v[76:79], v[110:113]
v_mfma_f32_16x16x32_f16 v[114:117], v[158:161], v[80:83], v[114:117]
v_mfma_f32_16x16x32_f16 v[110:113], v[162:165], v[90:93], v[110:113]
v_mfma_f32_16x16x32_f16 v[114:117], v[162:165], v[88:91], v[114:117]
v_mfma_f32_16x16x32_f16 v[118:121], v[162:165], v[86:89], 0
v_mfma_f32_16x16x32_f16 v[122:125], v[162:165], v[84:87], 0
s_waitcnt lgkmcnt(5)
v_mfma_f32_16x16x32_f16 v[146:149], v[142:145], v[20:23], 0
v_mfma_f32_16x16x32_f16 v[150:153], v[142:145], v[24:27], 0
v_mfma_f32_16x16x32_f16 v[154:157], v[142:145], v[28:31], 0
ds_read_b128 v[142:145], v15 offset:1536
ds_read_b128 v[138:141], v14 offset:1920
s_waitcnt lgkmcnt(6)
v_mfma_f32_16x16x32_f16 v[102:105], v[36:39], v[6:9], v[102:105]
v_mfma_f32_16x16x32_f16 v[106:109], v[52:55], v[6:9], v[106:109]
ds_read_b128 v[6:9], v14 offset:2048
s_waitcnt lgkmcnt(6)
v_mfma_f32_16x16x32_f16 v[102:105], v[32:35], v[2:5], v[102:105]
v_mfma_f32_16x16x32_f16 v[106:109], v[48:51], v[2:5], v[106:109]
v_mfma_f32_16x16x32_f16 v[110:113], v[64:67], v[2:5], v[110:113]
v_mfma_f32_16x16x32_f16 v[118:121], v[68:71], v[2:5], v[118:121]
ds_read_b128 v[2:5], v14 offset:2176
s_waitcnt lgkmcnt(6)
v_mfma_f32_16x16x32_f16 v[106:109], v[44:47], v[126:129], v[106:109]
v_cvt_pk_f16_f32 v158, v146, v147
v_mfma_f32_16x16x32_f16 v[110:113], v[60:63], v[126:129], v[110:113]
v_cvt_pk_f16_f32 v159, v148, v149
ds_read_b128 v[126:129], v14 offset:2304
s_waitcnt lgkmcnt(6)
v_mfma_f32_16x16x32_f16 v[106:109], v[40:43], v[130:133], v[106:109]
v_cvt_pk_f16_f32 v160, v150, v151
v_mfma_f32_16x16x32_f16 v[110:113], v[56:59], v[130:133], v[110:113]
v_cvt_pk_f16_f32 v161, v152, v153
ds_read_b128 v[130:133], v14 offset:2432
s_waitcnt lgkmcnt(6)
v_mfma_f32_16x16x32_f16 v[106:109], v[36:39], v[134:137], v[106:109]
v_cvt_pk_f16_f32 v162, v154, v155
v_mfma_f32_16x16x32_f16 v[110:113], v[52:55], v[134:137], v[110:113]
v_cvt_pk_f16_f32 v163, v156, v157
v_mfma_f32_16x16x32_f16 v[110:113], v[158:161], v[72:75], v[110:113]
v_mfma_f32_16x16x32_f16 v[114:117], v[158:161], v[76:79], v[114:117]
v_mfma_f32_16x16x32_f16 v[118:121], v[158:161], v[80:83], v[118:121]
s_waitcnt lgkmcnt(5)
v_mfma_f32_16x16x32_f16 v[146:149], v[142:145], v[20:23], 0
v_mfma_f32_16x16x32_f16 v[150:153], v[142:145], v[24:27], 0
v_mfma_f32_16x16x32_f16 v[154:157], v[142:145], v[28:31], 0
ds_read_b128 v[142:145], v15 offset:2048
ds_read_b128 v[134:137], v14 offset:2560
s_waitcnt lgkmcnt(6)
v_mfma_f32_16x16x32_f16 v[106:109], v[32:35], v[138:141], v[106:109]
v_mfma_f32_16x16x32_f16 v[110:113], v[48:51], v[138:141], v[110:113]
v_mfma_f32_16x16x32_f16 v[114:117], v[64:67], v[138:141], v[114:117]
v_mfma_f32_16x16x32_f16 v[122:125], v[68:71], v[138:141], v[122:125]
ds_read_b128 v[138:141], v14 offset:2688
s_waitcnt lgkmcnt(6)
v_mfma_f32_16x16x32_f16 v[110:113], v[44:47], v[6:9], v[110:113]
v_mfma_f32_16x16x32_f16 v[114:117], v[60:63], v[6:9], v[114:117]
ds_read_b128 v[6:9], v14 offset:2816
s_waitcnt lgkmcnt(6)
v_mfma_f32_16x16x32_f16 v[110:113], v[40:43], v[2:5], v[110:113]
v_cvt_pk_f16_f32 v158, v146, v147
v_mfma_f32_16x16x32_f16 v[114:117], v[56:59], v[2:5], v[114:117]
v_cvt_pk_f16_f32 v159, v148, v149
ds_read_b128 v[2:5], v14 offset:2944
s_waitcnt lgkmcnt(6)
v_mfma_f32_16x16x32_f16 v[110:113], v[36:39], v[126:129], v[110:113]
v_cvt_pk_f16_f32 v160, v150, v151
v_mfma_f32_16x16x32_f16 v[114:117], v[52:55], v[126:129], v[114:117]
v_cvt_pk_f16_f32 v161, v152, v153
ds_read_b128 v[126:129], v14 offset:3072
s_waitcnt lgkmcnt(6)
v_mfma_f32_16x16x32_f16 v[110:113], v[32:35], v[130:133], v[110:113]
v_cvt_pk_f16_f32 v164, v154, v155
v_mfma_f32_16x16x32_f16 v[114:117], v[48:51], v[130:133], v[114:117]
v_cvt_pk_f16_f32 v165, v156, v157
v_mfma_f32_16x16x32_f16 v[118:121], v[64:67], v[130:133], v[118:121]
v_mfma_f32_16x16x32_f16 v[114:117], v[158:161], v[72:75], v[114:117]
v_mfma_f32_16x16x32_f16 v[118:121], v[158:161], v[76:79], v[118:121]
v_mfma_f32_16x16x32_f16 v[122:125], v[158:161], v[80:83], v[122:125]
v_mfma_f32_16x16x32_f16 v[118:121], v[162:165], v[90:93], v[118:121]
v_mfma_f32_16x16x32_f16 v[122:125], v[162:165], v[88:91], v[122:125]
s_waitcnt lgkmcnt(5)
v_mfma_f32_16x16x32_f16 v[146:149], v[142:145], v[20:23], 0
v_mfma_f32_16x16x32_f16 v[150:153], v[142:145], v[24:27], 0
ds_read_b128 v[142:145], v15 offset:2560
ds_read_b128 v[130:133], v14 offset:3200
s_waitcnt lgkmcnt(6)
v_mfma_f32_16x16x32_f16 v[114:117], v[44:47], v[134:137], v[114:117]
v_mfma_f32_16x16x32_f16 v[118:121], v[60:63], v[134:137], v[118:121]
ds_read_b128 v[134:137], v14 offset:3328
s_waitcnt lgkmcnt(6)
v_mfma_f32_16x16x32_f16 v[114:117], v[40:43], v[138:141], v[114:117]
v_mfma_f32_16x16x32_f16 v[118:121], v[56:59], v[138:141], v[118:121]
ds_read_b128 v[138:141], v14 offset:3456
s_waitcnt lgkmcnt(6)
v_mfma_f32_16x16x32_f16 v[114:117], v[36:39], v[6:9], v[114:117]
v_cvt_pk_f16_f32 v158, v146, v147
v_mfma_f32_16x16x32_f16 v[118:121], v[52:55], v[6:9], v[118:121]
v_cvt_pk_f16_f32 v159, v148, v149
ds_read_b128 v[6:9], v14 offset:3584
s_waitcnt lgkmcnt(6)
v_mfma_f32_16x16x32_f16 v[114:117], v[32:35], v[2:5], v[114:117]
v_cvt_pk_f16_f32 v160, v150, v151
v_mfma_f32_16x16x32_f16 v[118:121], v[48:51], v[2:5], v[118:121]
v_cvt_pk_f16_f32 v161, v152, v153
v_mfma_f32_16x16x32_f16 v[122:125], v[64:67], v[2:5], v[122:125]
ds_read_b128 v[2:5], v14 offset:3712
s_waitcnt lgkmcnt(6)
v_mfma_f32_16x16x32_f16 v[118:121], v[44:47], v[126:129], v[118:121]
v_mfma_f32_16x16x32_f16 v[122:125], v[60:63], v[126:129], v[122:125]
v_mfma_f32_16x16x32_f16 v[118:121], v[158:161], v[72:75], v[118:121]
v_mfma_f32_16x16x32_f16 v[122:125], v[158:161], v[76:79], v[122:125]
s_waitcnt lgkmcnt(5)
v_mfma_f32_16x16x32_f16 v[146:149], v[142:145], v[20:23], 0
v_mfma_f32_16x16x32_f16 v[150:153], v[142:145], v[24:27], 0
ds_read_b128 v[126:129], v14 offset:3840
s_waitcnt lgkmcnt(5)
v_mfma_f32_16x16x32_f16 v[118:121], v[40:43], v[130:133], v[118:121]
v_mfma_f32_16x16x32_f16 v[122:125], v[56:59], v[130:133], v[122:125]
ds_read_b128 v[130:133], v14 offset:3968
s_waitcnt lgkmcnt(5)
v_mfma_f32_16x16x32_f16 v[118:121], v[36:39], v[134:137], v[118:121]
v_mfma_f32_16x16x32_f16 v[122:125], v[52:55], v[134:137], v[122:125]
s_waitcnt lgkmcnt(4)
v_mfma_f32_16x16x32_f16 v[118:121], v[32:35], v[138:141], v[118:121]
v_cvt_pk_f16_f32 v158, v146, v147
v_mfma_f32_16x16x32_f16 v[122:125], v[48:51], v[138:141], v[122:125]
v_cvt_pk_f16_f32 v159, v148, v149
s_waitcnt lgkmcnt(3)
v_mfma_f32_16x16x32_f16 v[122:125], v[44:47], v[6:9], v[122:125]
v_cvt_pk_f16_f32 v160, v150, v151
s_waitcnt lgkmcnt(2)
v_mfma_f32_16x16x32_f16 v[122:125], v[40:43], v[2:5], v[122:125]
v_cvt_pk_f16_f32 v161, v152, v153
s_nop 1
v_mfma_f32_16x16x32_f16 v[122:125], v[158:161], v[72:75], v[122:125]
s_waitcnt lgkmcnt(1)
v_mfma_f32_16x16x32_f16 v[122:125], v[36:39], v[126:129], v[122:125]
s_waitcnt lgkmcnt(0)
v_mfma_f32_16x16x32_f16 v[122:125], v[32:35], v[130:133], v[122:125]
s_mul_i32 s65, s23, 1179648
s_lshl_b32 s63, s24, 6
s_add_u32 s63, s63, s65
s_add_u32 s63, s63, 2359296
v_lshrrev_b32 v10, 6, v1
v_mul_u32_u24 v10, 36800, v10
v_add_u32 v1, v1, v10
s_cmp_eq_u32 s23, 1
s_nop 0
s_cbranch_scc1 CV_tail1
ds_write_b128 v12, v[110:113] offset:0
ds_write_b128 v12, v[114:117] offset:1024
ds_write_b128 v12, v[118:121] offset:2048
ds_write_b128 v12, v[122:125] offset:3072
ds_write_b32 v16, v19 offset:96
CV_poll4:
ds_read_b32 v18, v17
s_waitcnt lgkmcnt(0)
v_cmp_eq_u32 vcc, 0, v18
s_nop 1
s_and_b64 vcc, vcc, s[66:67]
s_cbranch_scc0 CV_poll4_ok
s_sleep 2
s_branch CV_poll4
CV_poll4_ok:
ds_read_b128 v[20:23], v13 offset:0
ds_read_b128 v[24:27], v13 offset:1024
ds_read_b128 v[28:31], v13 offset:2048
ds_read_b128 v[32:35], v13 offset:3072
s_waitcnt lgkmcnt(3)
v_add_f32 v94, v94, v20
v_add_f32 v95, v95, v21
v_add_f32 v96, v96, v22
v_add_f32 v97, v97, v23
v_ldexp_f32 v94, v94, s59
v_ldexp_f32 v95, v95, s59
v_ldexp_f32 v96, v96, s59
v_ldexp_f32 v97, v97, s59
v_cvt_pk_bf16_f32 v94, v94, v95
v_cvt_pk_bf16_f32 v95, v96, v97
buffer_store_dwordx2 v[94:95], v1, s[12:15], s63 offen sc1
s_add_u32 s63, s63, 294912
s_waitcnt lgkmcnt(2)
v_add_f32 v98, v98, v24
v_add_f32 v99, v99, v25
v_add_f32 v100, v100, v26
v_add_f32 v101, v101, v27
v_ldexp_f32 v98, v98, s59
v_ldexp_f32 v99, v99, s59
v_ldexp_f32 v100, v100, s59
v_ldexp_f32 v101, v101, s59
v_cvt_pk_bf16_f32 v98, v98, v99
v_cvt_pk_bf16_f32 v99, v100, v101
buffer_store_dwordx2 v[98:99], v1, s[12:15], s63 offen sc1
s_add_u32 s63, s63, 294912
s_waitcnt lgkmcnt(1)
v_add_f32 v102, v102, v28
v_add_f32 v103, v103, v29
v_add_f32 v104, v104, v30
v_add_f32 v105, v105, v31
v_ldexp_f32 v102, v102, s59
v_ldexp_f32 v103, v103, s59
v_ldexp_f32 v104, v104, s59
v_ldexp_f32 v105, v105, s59
v_cvt_pk_bf16_f32 v102, v102, v103
v_cvt_pk_bf16_f32 v103, v104, v105
buffer_store_dwordx2 v[102:103], v1, s[12:15], s63 offen sc1
s_add_u32 s63, s63, 294912
s_waitcnt lgkmcnt(0)
v_add_f32 v106, v106, v32
v_add_f32 v107, v107, v33
v_add_f32 v108, v108, v34
v_add_f32 v109, v109, v35
v_ldexp_f32 v106, v106, s59
v_ldexp_f32 v107, v107, s59
v_ldexp_f32 v108, v108, s59
v_ldexp_f32 v109, v109, s59
v_cvt_pk_bf16_f32 v106, v106, v107
v_cvt_pk_bf16_f32 v107, v108, v109
buffer_store_dwordx2 v[106:107], v1, s[12:15], s63 offen sc1
s_add_u32 s63, s63, 294912
s_endpgm
CV_tail1:
ds_write_b128 v12, v[94:97] offset:0
ds_write_b128 v12, v[98:101] offset:1024
ds_write_b128 v12, v[102:105] offset:2048
ds_write_b128 v12, v[106:109] offset:3072
ds_write_b32 v16, v19 offset:96
CV_poll5:
ds_read_b32 v18, v17
s_waitcnt lgkmcnt(0)
v_cmp_eq_u32 vcc, 0, v18
s_nop 1
s_and_b64 vcc, vcc, s[66:67]
s_cbranch_scc0 CV_poll5_ok
s_sleep 2
s_branch CV_poll5
CV_poll5_ok:
ds_read_b128 v[20:23], v13 offset:0
ds_read_b128 v[24:27], v13 offset:1024
ds_read_b128 v[28:31], v13 offset:2048
ds_read_b128 v[32:35], v13 offset:3072
s_waitcnt lgkmcnt(3)
v_add_f32 v110, v110, v20
v_add_f32 v111, v111, v21
v_add_f32 v112, v112, v22
v_add_f32 v113, v113, v23
v_ldexp_f32 v110, v110, s59
v_ldexp_f32 v111, v111, s59
v_ldexp_f32 v112, v112, s59
v_ldexp_f32 v113, v113, s59
v_cvt_pk_bf16_f32 v110, v110, v111
v_cvt_pk_bf16_f32 v111, v112, v113
buffer_store_dwordx2 v[110:111], v1, s[12:15], s63 offen sc1
s_add_u32 s63, s63, 294912
s_waitcnt lgkmcnt(2)
v_add_f32 v114, v114, v24
v_add_f32 v115, v115, v25
v_add_f32 v116, v116, v26
v_add_f32 v117, v117, v27
v_ldexp_f32 v114, v114, s59
v_ldexp_f32 v115, v115, s59
v_ldexp_f32 v116, v116, s59
v_ldexp_f32 v117, v117, s59
v_cvt_pk_bf16_f32 v114, v114, v115
v_cvt_pk_bf16_f32 v115, v116, v117
buffer_store_dwordx2 v[114:115], v1, s[12:15], s63 offen sc1
s_add_u32 s63, s63, 294912
s_waitcnt lgkmcnt(1)
v_add_f32 v118, v118, v28
v_add_f32 v119, v119, v29
v_add_f32 v120, v120, v30
v_add_f32 v121, v121, v31
v_ldexp_f32 v118, v118, s59
v_ldexp_f32 v119, v119, s59
v_ldexp_f32 v120, v120, s59
v_ldexp_f32 v121, v121, s59
v_cvt_pk_bf16_f32 v118, v118, v119
v_cvt_pk_bf16_f32 v119, v120, v121
buffer_store_dwordx2 v[118:119], v1, s[12:15], s63 offen sc1
s_add_u32 s63, s63, 294912
s_waitcnt lgkmcnt(0)
v_add_f32 v122, v122, v32
v_add_f32 v123, v123, v33
v_add_f32 v124, v124, v34
v_add_f32 v125, v125, v35
v_ldexp_f32 v122, v122, s59
v_ldexp_f32 v123, v123, s59
v_ldexp_f32 v124, v124, s59
v_ldexp_f32 v125, v125, s59
v_cvt_pk_bf16_f32 v122, v122, v123
v_cvt_pk_bf16_f32 v123, v124, v125
buffer_store_dwordx2 v[122:123], v1, s[12:15], s63 offen sc1
s_add_u32 s63, s63, 294912
s_endpgm
K1_notconv:
s_cmp_ge_u32 s17, 30
s_cbranch_scc1 K1_aux
s_cmp_ge_u32 s20, 8
s_cbranch_scc1 GM_exit
s_load_dwordx4 s[4:7], s[0:1], 0
s_load_dwordx4 s[36:39], s[0:1], 112
v_and_b32 v1, 63, v0
s_sub_u32 s21, s17, 12
s_and_b32 s22, s16, 3
s_lshl_b32 s22, s22, 2
s_lshr_b32 s23, s16, 2
s_and_b32 s24, s21, 3
s_lshr_b32 s25, s21, 2
s_lshl_b32 s26, s23, 1
s_add_u32 s26, s26, s24
s_mul_i32 s27, s23, 5
s_add_u32 s27, s27, s25
s_cmp_ge_u32 s21, 16
s_cselect_b32 s24, s26, s24
s_cselect_b32 s27, 4, s27
s_add_u32 s28, s22, s24
s_add_u32 s29, s24, s25
s_lshl_b32 s29, s29, 1
s_cmp_ge_u32 s29, 9
s_cselect_b32 s30, 9, 0
s_sub_u32 s29, s29, s30
s_cmp_lt_u32 s20, 4
s_cbranch_scc1 GM_cons
s_sub_u32 s48, s20, 4
v_lshrrev_b32 v2, 3, v1
v_mul_u32_u24 v2, 1152, v2
v_and_b32 v3, 7, v1
v_bfe_u32 v4, v1, 4, 1
v_xor_b32 v3, v3, v4
v_lshl_add_u32 v6, v3, 4, v2
v_xor_b32 v7, 32, v6
v_xor_b32 v8, 64, v6
v_xor_b32 v9, 0x60, v6
s_lshl_b32 s49, s28, 7
s_lshl_b32 s50, s48, 5
s_add_u32 s49, s49, s50
s_mul_i32 s49, s49, 1152
s_lshl_b32 s50, s48, 12
s_mul_i32 s51, s48, 55296
s_mul_i32 s52, s48, 6144
s_add_u32 s52, s52, 49152
s_mul_i32 s53, s27, 144
s_add_u32 s54, s53, 2160
s_add_u32 s53, s53, 1152
s_mul_i32 s55, s27, 96
s_sub_u32 s55, s55, 288
s_cmp_eq_u32 s27, 8
s_cselect_b32 s53, 768, s53
s_cselect_b32 s54, 768, s54
s_cselect_b32 s55, 768, s55
s_add_u32 s56, s29, 0
s_cmp_ge_u32 s56, 9
s_cselect_b32 s60, 9, 0
s_sub_u32 s56, s56, s60
s_add_u32 s56, s56, 0
s_lshl_b32 s57, s56, 7
s_add_u32 s57, s57, s49
s_mul_i32 s58, s56, 221184
s_add_u32 s58, s58, s51
s_mov_b32 s60, 2731
v_add_u32 v2, 0, v1
v_mul_lo_u32 v3, v2, s60
v_lshrrev_b32 v3, 16, v3
v_mul_u32_u24 v4, 24, v3
v_sub_u32 v2, v2, v4
v_and_b32 v4, 2, v3
v_lshrrev_b32 v5, 1, v3
v_and_b32 v5, 4, v5
v_or_b32 v4, v4, v5
v_xor_b32 v2, v2, v4
v_mov_b32 v4, s53
v_mov_b32 v5, s54
v_cmp_lt_u32 vcc, 8, v2
s_nop 1
v_cndmask_b32 v4, v4, v5, vcc
v_mov_b32 v5, s55
v_cmp_lt_u32 vcc, 17, v2
s_nop 1
v_cndmask_b32 v4, v4, v5, vcc
v_lshl_add_u32 v4, v2, 4, v4
v_mul_u32_u24 v3, 3456, v3
v_add_u32 v10, v3, v4
v_add_u32 v2, 64, v1
v_mul_lo_u32 v3, v2, s60
v_lshrrev_b32 v3, 16, v3
v_mul_u32_u24 v4, 24, v3
v_sub_u32 v2, v2, v4
v_and_b32 v4, 2, v3
v_lshrrev_b32 v5, 1, v3
v_and_b32 v5, 4, v5
v_or_b32 v4, v4, v5
v_xor_b32 v2, v2, v4
v_mov_b32 v4, s53
v_mov_b32 v5, s54
v_cmp_lt_u32 vcc, 8, v2
s_nop 1
v_cndmask_b32 v4, v4, v5, vcc
v_mov_b32 v5, s55
v_cmp_lt_u32 vcc, 17, v2
s_nop 1
v_cndmask_b32 v4, v4, v5, vcc
v_lshl_add_u32 v4, v2, 4, v4
v_mul_u32_u24 v3, 3456, v3
v_add_u32 v11, v3, v4
s_waitcnt lgkmcnt(0)
s_mov_b32 s8, s4
s_mov_b32 s9, s5
s_mov_b32 s10, 2359296
s_mov_b32 s11, 0x20000
s_mov_b32 s12, s6
s_mov_b32 s13, s7
s_mov_b32 s14, 1990656
s_mov_b32 s15, 0x20000
s_mov_b32 s40, s38
s_mov_b32 s41, s39
s_mov_b32 s42, 5570560
s_mov_b32 s43, 0x20000
s_mov_b32 s44, s36
s_mov_b32 s45, s37
s_mov_b32 s46, 256
s_mov_b32 s47, 0x20000
s_add_u32 s59, s57, 0
s_add_u32 m0, s50, 0
s_nop 0
buffer_load_dwordx4 v6, s[8:11], s59 offen lds
s_add_u32 s59, s57, 9216
s_add_u32 m0, s50, 1024
s_nop 0
buffer_load_dwordx4 v7, s[8:11], s59 offen lds
s_add_u32 s59, s57, 18432
s_add_u32 m0, s50, 2048
s_nop 0
buffer_load_dwordx4 v8, s[8:11], s59 offen lds
s_add_u32 s59, s57, 27648
s_add_u32 m0, s50, 3072
s_nop 0
buffer_load_dwordx4 v9, s[8:11], s59 offen lds
s_add_u32 m0, s52, 0
s_nop 0
buffer_load_dwordx4 v10, s[12:15], s58 offen lds
s_add_u32 m0, s52, 1024
s_nop 0
buffer_load_dwordx4 v11, s[12:15], s58 offen lds
v_add_u32 v2, 128, v1
v_mul_lo_u32 v3, v2, s60
v_lshrrev_b32 v3, 16, v3
v_mul_u32_u24 v4, 24, v3
v_sub_u32 v2, v2, v4
v_and_b32 v4, 2, v3
v_lshrrev_b32 v5, 1, v3
v_and_b32 v5, 4, v5
v_or_b32 v4, v4, v5
v_xor_b32 v2, v2, v4
v_mov_b32 v4, s53
v_mov_b32 v5, s54
v_cmp_lt_u32 vcc, 8, v2
s_nop 1
v_cndmask_b32 v4, v4, v5, vcc
v_mov_b32 v5, s55
v_cmp_lt_u32 vcc, 17, v2
s_nop 1
v_cndmask_b32 v4, v4, v5, vcc
v_lshl_add_u32 v4, v2, 4, v4
v_mul_u32_u24 v3, 3456, v3
v_add_u32 v12, v3, v4
s_add_u32 m0, s52, 2048
s_nop 0
buffer_load_dwordx4 v12, s[12:15], s58 offen lds
v_add_u32 v2, 192, v1
v_mul_lo_u32 v3, v2, s60
v_lshrrev_b32 v3, 16, v3
v_mul_u32_u24 v4, 24, v3
v_sub_u32 v2, v2, v4
v_and_b32 v4, 2, v3
v_lshrrev_b32 v5, 1, v3
v_and_b32 v5, 4, v5
v_or_b32 v4, v4, v5
v_xor_b32 v2, v2, v4
v_mov_b32 v4, s53
v_mov_b32 v5, s54
v_cmp_lt_u32 vcc, 8, v2
s_nop 1
v_cndmask_b32 v4, v4, v5, vcc
v_mov_b32 v5, s55
v_cmp_lt_u32 vcc, 17, v2
s_nop 1
v_cndmask_b32 v4, v4, v5, vcc
v_lshl_add_u32 v4, v2, 4, v4
v_mul_u32_u24 v3, 3456, v3
v_add_u32 v13, v3, v4
s_add_u32 m0, s52, 3072
s_nop 0
buffer_load_dwordx4 v13, s[12:15], s58 offen lds
v_add_u32 v2, 256, v1
v_mul_lo_u32 v3, v2, s60
v_lshrrev_b32 v3, 16, v3
v_mul_u32_u24 v4, 24, v3
v_sub_u32 v2, v2, v4
v_and_b32 v4, 2, v3
v_lshrrev_b32 v5, 1, v3
v_and_b32 v5, 4, v5
v_or_b32 v4, v4, v5
v_xor_b32 v2, v2, v4
v_mov_b32 v4, s53
v_mov_b32 v5, s54
v_cmp_lt_u32 vcc, 8, v2
s_nop 1
v_cndmask_b32 v4, v4, v5, vcc
v_mov_b32 v5, s55
v_cmp_lt_u32 vcc, 17, v2
s_nop 1
v_cndmask_b32 v4, v4, v5, vcc
v_lshl_add_u32 v4, v2, 4, v4
v_mul_u32_u24 v3, 3456, v3
v_add_u32 v14, v3, v4
s_add_u32 m0, s52, 4096
s_nop 0
buffer_load_dwordx4 v14, s[12:15], s58 offen lds
v_add_u32 v2, 320, v1
v_mul_lo_u32 v3, v2, s60
v_lshrrev_b32 v3, 16, v3
v_mul_u32_u24 v4, 24, v3
v_sub_u32 v2, v2, v4
v_and_b32 v4, 2, v3
v_lshrrev_b32 v5, 1, v3
v_and_b32 v5, 4, v5
v_or_b32 v4, v4, v5
v_xor_b32 v2, v2, v4
v_mov_b32 v4, s53
v_mov_b32 v5, s54
v_cmp_lt_u32 vcc, 8, v2
s_nop 1
v_cndmask_b32 v4, v4, v5, vcc
v_mov_b32 v5, s55
v_cmp_lt_u32 vcc, 17, v2
s_nop 1
v_cndmask_b32 v4, v4, v5, vcc
v_lshl_add_u32 v4, v2, 4, v4
v_mul_u32_u24 v3, 3456, v3
v_add_u32 v15, v3, v4
s_add_u32 m0, s52, 5120
s_nop 0
buffer_load_dwordx4 v15, s[12:15], s58 offen lds
s_barrier
s_add_u32 s56, s29, 1
s_cmp_ge_u32 s56, 9
s_cselect_b32 s60, 9, 0
s_sub_u32 s56, s56, s60
s_add_u32 s56, s56, 0
s_lshl_b32 s57, s56, 7
s_add_u32 s57, s57, s49
s_mul_i32 s58, s56, 221184
s_add_u32 s58, s58, s51
s_add_u32 s59, s57, 0
s_add_u32 m0, s50, 16384
s_nop 0
buffer_load_dwordx4 v6, s[8:11], s59 offen lds
s_add_u32 s59, s57, 9216
s_add_u32 m0, s50, 17408
s_nop 0
buffer_load_dwordx4 v7, s[8:11], s59 offen lds
s_add_u32 s59, s57, 18432
s_add_u32 m0, s50, 18432
s_nop 0
buffer_load_dwordx4 v8, s[8:11], s59 offen lds
s_add_u32 s59, s57, 27648
s_add_u32 m0, s50, 19456
s_nop 0
buffer_load_dwordx4 v9, s[8:11], s59 offen lds
s_add_u32 m0, s52, 24576
s_nop 0
buffer_load_dwordx4 v10, s[12:15], s58 offen lds
s_add_u32 m0, s52, 25600
s_nop 0
buffer_load_dwordx4 v11, s[12:15], s58 offen lds
s_add_u32 m0, s52, 26624
s_nop 0
buffer_load_dwordx4 v12, s[12:15], s58 offen lds
s_add_u32 m0, s52, 27648
s_nop 0
buffer_load_dwordx4 v13, s[12:15], s58 offen lds
s_add_u32 m0, s52, 28672
s_nop 0
buffer_load_dwordx4 v14, s[12:15], s58 offen lds
s_add_u32 m0, s52, 29696
s_nop 0
buffer_load_dwordx4 v15, s[12:15], s58 offen lds
s_load_dwordx2 s[62:63], s[0:1], 96
s_cmp_eq_u32 s27, 8
s_cselect_b32 s61, s48, 9
v_bfe_u32 v2, v1, 1, 1
v_lshrrev_b32 v3, 2, v1
v_and_b32 v3, 6, v3
v_or_b32 v2, v2, v3
v_lshlrev_b32 v2, 4, v2
v_lshl_add_u32 v16, v1, 7, v2
s_lshl_b32 s60, s48, 13
v_add_u32 v16, s60, v16
v_mov_b32 v18, 0
v_mov_b32 v19, 0
s_waitcnt lgkmcnt(0)
s_waitcnt vmcnt(10)
s_add_u32 s56, s29, 0
s_cmp_ge_u32 s56, 9
s_cselect_b32 s60, 9, 0
s_sub_u32 s56, s56, s60
s_add_u32 s56, s56, 0
s_lshl_b32 s56, s56, 7
s_load_dwordx16 s[64:79], s[62:63], s56
s_add_u32 s56, s56, 64
s_load_dwordx16 s[80:95], s[62:63], s56
s_barrier
s_add_u32 s56, s29, 2
s_cmp_ge_u32 s56, 9
s_cselect_b32 s60, 9, 0
s_sub_u32 s56, s56, s60
s_add_u32 s56, s56, 0
s_lshl_b32 s57, s56, 7
s_add_u32 s57, s57, s49
s_mul_i32 s58, s56, 221184
s_add_u32 s58, s58, s51
s_add_u32 s59, s57, 0
s_add_u32 m0, s50, 32768
s_nop 0
buffer_load_dwordx4 v6, s[8:11], s59 offen lds
s_add_u32 s59, s57, 9216
s_add_u32 m0, s50, 33792
s_nop 0
buffer_load_dwordx4 v7, s[8:11], s59 offen lds
s_add_u32 s59, s57, 18432
s_add_u32 m0, s50, 34816
s_nop 0
buffer_load_dwordx4 v8, s[8:11], s59 offen lds
s_add_u32 s59, s57, 27648
s_add_u32 m0, s50, 35840
s_nop 0
buffer_load_dwordx4 v9, s[8:11], s59 offen lds
s_add_u32 m0, s52, 49152
s_nop 0
buffer_load_dwordx4 v10, s[12:15], s58 offen lds
s_add_u32 m0, s52, 50176
s_nop 0
buffer_load_dwordx4 v11, s[12:15], s58 offen lds
s_add_u32 m0, s52, 51200
s_nop 0
buffer_load_dwordx4 v12, s[12:15], s58 offen lds
s_add_u32 m0, s52, 52224
s_nop 0
buffer_load_dwordx4 v13, s[12:15], s58 offen lds
s_add_u32 m0, s52, 53248
s_nop 0
buffer_load_dwordx4 v14, s[12:15], s58 offen lds
s_add_u32 m0, s52, 54272
s_nop 0
buffer_load_dwordx4 v15, s[12:15], s58 offen lds
s_cmp_ge_u32 s61, 2
s_cbranch_scc1 GM_nogate0
v_add_u32 v52, 0, v16
v_xor_b32 v53, 16, v52
v_xor_b32 v54, 32, v52
v_xor_b32 v55, 48, v52
v_xor_b32 v56, 64, v52
v_xor_b32 v57, 80, v52
v_xor_b32 v58, 96, v52
v_xor_b32 v59, 112, v52
ds_read_b128 v[20:23], v52
ds_read_b128 v[24:27], v53
ds_read_b128 v[28:31], v54
ds_read_b128 v[32:35], v55
ds_read_b128 v[36:39], v56
ds_read_b128 v[40:43], v57
ds_read_b128 v[44:47], v58
ds_read_b128 v[48:51], v59
s_waitcnt lgkmcnt(0)
v_dot2c_f32_bf16 v18, s64, v20
v_dot2c_f32_bf16 v19, s65, v21
v_dot2c_f32_bf16 v18, s66, v22
v_dot2c_f32_bf16 v19, s67, v23
v_dot2c_f32_bf16 v18, s68, v24
v_dot2c_f32_bf16 v19, s69, v25
v_dot2c_f32_bf16 v18, s70, v26
v_dot2c_f32_bf16 v19, s71, v27
v_dot2c_f32_bf16 v18, s72, v28
v_dot2c_f32_bf16 v19, s73, v29
v_dot2c_f32_bf16 v18, s74, v30
v_dot2c_f32_bf16 v19, s75, v31
v_dot2c_f32_bf16 v18, s76, v32
v_dot2c_f32_bf16 v19, s77, v33
v_dot2c_f32_bf16 v18, s78, v34
v_dot2c_f32_bf16 v19, s79, v35
v_dot2c_f32_bf16 v18, s80, v36
v_dot2c_f32_bf16 v19, s81, v37
v_dot2c_f32_bf16 v18, s82, v38
v_dot2c_f32_bf16 v19, s83, v39
v_dot2c_f32_bf16 v18, s84, v40
v_dot2c_f32_bf16 v19, s85, v41
v_dot2c_f32_bf16 v18, s86, v42
v_dot2c_f32_bf16 v19, s87, v43
v_dot2c_f32_bf16 v18, s88, v44
v_dot2c_f32_bf16 v19, s89, v45
v_dot2c_f32_bf16 v18, s90, v46
v_dot2c_f32_bf16 v19, s91, v47
v_dot2c_f32_bf16 v18, s92, v48
v_dot2c_f32_bf16 v19, s93, v49
v_dot2c_f32_bf16 v18, s94, v50
v_dot2c_f32_bf16 v19, s95, v51
s_add_u32 s56, s29, 1
s_cmp_ge_u32 s56, 9
s_cselect_b32 s60, 9, 0
s_sub_u32 s56, s56, s60
s_add_u32 s56, s56, 0
s_lshl_b32 s56, s56, 7
s_load_dwordx16 s[64:79], s[62:63], s56
s_add_u32 s56, s56, 64
s_load_dwordx16 s[80:95], s[62:63], s56
s_nop 1
GM_nogate0:
s_waitcnt vmcnt(10)
s_barrier
s_add_u32 s56, s29, 3
s_cmp_ge_u32 s56, 9
s_cselect_b32 s60, 9, 0
s_sub_u32 s56, s56, s60
s_add_u32 s56, s56, 0
s_lshl_b32 s57, s56, 7
s_add_u32 s57, s57, s49
s_mul_i32 s58, s56, 221184
s_add_u32 s58, s58, s51
s_add_u32 s59, s57, 0
s_add_u32 m0, s50, 0
s_nop 0
buffer_load_dwordx4 v6, s[8:11], s59 offen lds
s_add_u32 s59, s57, 9216
s_add_u32 m0, s50, 1024
s_nop 0
buffer_load_dwordx4 v7, s[8:11], s59 offen lds
s_add_u32 s59, s57, 18432
s_add_u32 m0, s50, 2048
s_nop 0
buffer_load_dwordx4 v8, s[8:11], s59 offen lds
s_add_u32 s59, s57, 27648
s_add_u32 m0, s50, 3072
s_nop 0
buffer_load_dwordx4 v9, s[8:11], s59 offen lds
s_add_u32 m0, s52, 0
s_nop 0
buffer_load_dwordx4 v10, s[12:15], s58 offen lds
s_add_u32 m0, s52, 1024
s_nop 0
buffer_load_dwordx4 v11, s[12:15], s58 offen lds
s_add_u32 m0, s52, 2048
s_nop 0
buffer_load_dwordx4 v12, s[12:15], s58 offen lds
s_add_u32 m0, s52, 3072
s_nop 0
buffer_load_dwordx4 v13, s[12:15], s58 offen lds
s_add_u32 m0, s52, 4096
s_nop 0
buffer_load_dwordx4 v14, s[12:15], s58 offen lds
s_add_u32 m0, s52, 5120
s_nop 0
buffer_load_dwordx4 v15, s[12:15], s58 offen lds
s_cmp_ge_u32 s61, 2
s_cbranch_scc1 GM_nogate1
v_add_u32 v52, 16384, v16
v_xor_b32 v53, 16, v52
v_xor_b32 v54, 32, v52
v_xor_b32 v55, 48, v52
v_xor_b32 v56, 64, v52
v_xor_b32 v57, 80, v52
v_xor_b32 v58, 96, v52
v_xor_b32 v59, 112, v52
ds_read_b128 v[20:23], v52
ds_read_b128 v[24:27], v53
ds_read_b128 v[28:31], v54
ds_read_b128 v[32:35], v55
ds_read_b128 v[36:39], v56
ds_read_b128 v[40:43], v57
ds_read_b128 v[44:47], v58
ds_read_b128 v[48:51], v59
s_waitcnt lgkmcnt(0)
v_dot2c_f32_bf16 v18, s64, v20
v_dot2c_f32_bf16 v19, s65, v21
v_dot2c_f32_bf16 v18, s66, v22
v_dot2c_f32_bf16 v19, s67, v23
v_dot2c_f32_bf16 v18, s68, v24
v_dot2c_f32_bf16 v19, s69, v25
v_dot2c_f32_bf16 v18, s70, v26
v_dot2c_f32_bf16 v19, s71, v27
v_dot2c_f32_bf16 v18, s72, v28
v_dot2c_f32_bf16 v19, s73, v29
v_dot2c_f32_bf16 v18, s74, v30
v_dot2c_f32_bf16 v19, s75, v31
v_dot2c_f32_bf16 v18, s76, v32
v_dot2c_f32_bf16 v19, s77, v33
v_dot2c_f32_bf16 v18, s78, v34
v_dot2c_f32_bf16 v19, s79, v35
v_dot2c_f32_bf16 v18, s80, v36
v_dot2c_f32_bf16 v19, s81, v37
v_dot2c_f32_bf16 v18, s82, v38
v_dot2c_f32_bf16 v19, s83, v39
v_dot2c_f32_bf16 v18, s84, v40
v_dot2c_f32_bf16 v19, s85, v41
v_dot2c_f32_bf16 v18, s86, v42
v_dot2c_f32_bf16 v19, s87, v43
v_dot2c_f32_bf16 v18, s88, v44
v_dot2c_f32_bf16 v19, s89, v45
v_dot2c_f32_bf16 v18, s90, v46
v_dot2c_f32_bf16 v19, s91, v47
v_dot2c_f32_bf16 v18, s92, v48
v_dot2c_f32_bf16 v19, s93, v49
v_dot2c_f32_bf16 v18, s94, v50
v_dot2c_f32_bf16 v19, s95, v51
s_add_u32 s56, s29, 2
s_cmp_ge_u32 s56, 9
s_cselect_b32 s60, 9, 0
s_sub_u32 s56, s56, s60
s_add_u32 s56, s56, 0
s_lshl_b32 s56, s56, 7
s_load_dwordx16 s[64:79], s[62:63], s56
s_add_u32 s56, s56, 64
s_load_dwordx16 s[80:95], s[62:63], s56
s_nop 1
GM_nogate1:
s_waitcnt vmcnt(10)
s_barrier
s_add_u32 s56, s29, 4
s_cmp_ge_u32 s56, 9
s_cselect_b32 s60, 9, 0
s_sub_u32 s56, s56, s60
s_add_u32 s56, s56, 0
s_lshl_b32 s57, s56, 7
s_add_u32 s57, s57, s49
s_mul_i32 s58, s56, 221184
s_add_u32 s58, s58, s51
s_add_u32 s59, s57, 0
s_add_u32 m0, s50, 16384
s_nop 0
buffer_load_dwordx4 v6, s[8:11], s59 offen lds
s_add_u32 s59, s57, 9216
s_add_u32 m0, s50, 17408
s_nop 0
buffer_load_dwordx4 v7, s[8:11], s59 offen lds
s_add_u32 s59, s57, 18432
s_add_u32 m0, s50, 18432
s_nop 0
buffer_load_dwordx4 v8, s[8:11], s59 offen lds
s_add_u32 s59, s57, 27648
s_add_u32 m0, s50, 19456
s_nop 0
buffer_load_dwordx4 v9, s[8:11], s59 offen lds
s_add_u32 m0, s52, 24576
s_nop 0
buffer_load_dwordx4 v10, s[12:15], s58 offen lds
s_add_u32 m0, s52, 25600
s_nop 0
buffer_load_dwordx4 v11, s[12:15], s58 offen lds
s_add_u32 m0, s52, 26624
s_nop 0
buffer_load_dwordx4 v12, s[12:15], s58 offen lds
s_add_u32 m0, s52, 27648
s_nop 0
buffer_load_dwordx4 v13, s[12:15], s58 offen lds
s_add_u32 m0, s52, 28672
s_nop 0
buffer_load_dwordx4 v14, s[12:15], s58 offen lds
s_add_u32 m0, s52, 29696
s_nop 0
buffer_load_dwordx4 v15, s[12:15], s58 offen lds
s_cmp_ge_u32 s61, 2
s_cbranch_scc1 GM_nogate2
v_add_u32 v52, 32768, v16
v_xor_b32 v53, 16, v52
v_xor_b32 v54, 32, v52
v_xor_b32 v55, 48, v52
v_xor_b32 v56, 64, v52
v_xor_b32 v57, 80, v52
v_xor_b32 v58, 96, v52
v_xor_b32 v59, 112, v52
ds_read_b128 v[20:23], v52
ds_read_b128 v[24:27], v53
ds_read_b128 v[28:31], v54
ds_read_b128 v[32:35], v55
ds_read_b128 v[36:39], v56
ds_read_b128 v[40:43], v57
ds_read_b128 v[44:47], v58
ds_read_b128 v[48:51], v59
s_waitcnt lgkmcnt(0)
v_dot2c_f32_bf16 v18, s64, v20
v_dot2c_f32_bf16 v19, s65, v21
v_dot2c_f32_bf16 v18, s66, v22
v_dot2c_f32_bf16 v19, s67, v23
v_dot2c_f32_bf16 v18, s68, v24
v_dot2c_f32_bf16 v19, s69, v25
v_dot2c_f32_bf16 v18, s70, v26
v_dot2c_f32_bf16 v19, s71, v27
v_dot2c_f32_bf16 v18, s72, v28
v_dot2c_f32_bf16 v19, s73, v29
v_dot2c_f32_bf16 v18, s74, v30
v_dot2c_f32_bf16 v19, s75, v31
v_dot2c_f32_bf16 v18, s76, v32
v_dot2c_f32_bf16 v19, s77, v33
v_dot2c_f32_bf16 v18, s78, v34
v_dot2c_f32_bf16 v19, s79, v35
v_dot2c_f32_bf16 v18, s80, v36
v_dot2c_f32_bf16 v19, s81, v37
v_dot2c_f32_bf16 v18, s82, v38
v_dot2c_f32_bf16 v19, s83, v39
v_dot2c_f32_bf16 v18, s84, v40
v_dot2c_f32_bf16 v19, s85, v41
v_dot2c_f32_bf16 v18, s86, v42
v_dot2c_f32_bf16 v19, s87, v43
v_dot2c_f32_bf16 v18, s88, v44
v_dot2c_f32_bf16 v19, s89, v45
v_dot2c_f32_bf16 v18, s90, v46
v_dot2c_f32_bf16 v19, s91, v47
v_dot2c_f32_bf16 v18, s92, v48
v_dot2c_f32_bf16 v19, s93, v49
v_dot2c_f32_bf16 v18, s94, v50
v_dot2c_f32_bf16 v19, s95, v51
s_add_u32 s56, s29, 3
s_cmp_ge_u32 s56, 9
s_cselect_b32 s60, 9, 0
s_sub_u32 s56, s56, s60
s_add_u32 s56, s56, 0
s_lshl_b32 s56, s56, 7
s_load_dwordx16 s[64:79], s[62:63], s56
s_add_u32 s56, s56, 64
s_load_dwordx16 s[80:95], s[62:63], s56
s_nop 1
GM_nogate2:
s_waitcnt vmcnt(10)
s_barrier
s_add_u32 s56, s29, 5
s_cmp_ge_u32 s56, 9
s_cselect_b32 s60, 9, 0
s_sub_u32 s56, s56, s60
s_add_u32 s56, s56, 0
s_lshl_b32 s57, s56, 7
s_add_u32 s57, s57, s49
s_mul_i32 s58, s56, 221184
s_add_u32 s58, s58, s51
s_add_u32 s59, s57, 0
s_add_u32 m0, s50, 32768
s_nop 0
buffer_load_dwordx4 v6, s[8:11], s59 offen lds
s_add_u32 s59, s57, 9216
s_add_u32 m0, s50, 33792
s_nop 0
buffer_load_dwordx4 v7, s[8:11], s59 offen lds
s_add_u32 s59, s57, 18432
s_add_u32 m0, s50, 34816
s_nop 0
buffer_load_dwordx4 v8, s[8:11], s59 offen lds
s_add_u32 s59, s57, 27648
s_add_u32 m0, s50, 35840
s_nop 0
buffer_load_dwordx4 v9, s[8:11], s59 offen lds
s_add_u32 m0, s52, 49152
s_nop 0
buffer_load_dwordx4 v10, s[12:15], s58 offen lds
s_add_u32 m0, s52, 50176
s_nop 0
buffer_load_dwordx4 v11, s[12:15], s58 offen lds
s_add_u32 m0, s52, 51200
s_nop 0
buffer_load_dwordx4 v12, s[12:15], s58 offen lds
s_add_u32 m0, s52, 52224
s_nop 0
buffer_load_dwordx4 v13, s[12:15], s58 offen lds
s_add_u32 m0, s52, 53248
s_nop 0
buffer_load_dwordx4 v14, s[12:15], s58 offen lds
s_add_u32 m0, s52, 54272
s_nop 0
buffer_load_dwordx4 v15, s[12:15], s58 offen lds
s_cmp_ge_u32 s61, 2
s_cbranch_scc1 GM_nogate3
v_add_u32 v52, 0, v16
v_xor_b32 v53, 16, v52
v_xor_b32 v54, 32, v52
v_xor_b32 v55, 48, v52
v_xor_b32 v56, 64, v52
v_xor_b32 v57, 80, v52
v_xor_b32 v58, 96, v52
v_xor_b32 v59, 112, v52
ds_read_b128 v[20:23], v52
ds_read_b128 v[24:27], v53
ds_read_b128 v[28:31], v54
ds_read_b128 v[32:35], v55
ds_read_b128 v[36:39], v56
ds_read_b128 v[40:43], v57
ds_read_b128 v[44:47], v58
ds_read_b128 v[48:51], v59
s_waitcnt lgkmcnt(0)
v_dot2c_f32_bf16 v18, s64, v20
v_dot2c_f32_bf16 v19, s65, v21
v_dot2c_f32_bf16 v18, s66, v22
v_dot2c_f32_bf16 v19, s67, v23
v_dot2c_f32_bf16 v18, s68, v24
v_dot2c_f32_bf16 v19, s69, v25
v_dot2c_f32_bf16 v18, s70, v26
v_dot2c_f32_bf16 v19, s71, v27
v_dot2c_f32_bf16 v18, s72, v28
v_dot2c_f32_bf16 v19, s73, v29
v_dot2c_f32_bf16 v18, s74, v30
v_dot2c_f32_bf16 v19, s75, v31
v_dot2c_f32_bf16 v18, s76, v32
v_dot2c_f32_bf16 v19, s77, v33
v_dot2c_f32_bf16 v18, s78, v34
v_dot2c_f32_bf16 v19, s79, v35
v_dot2c_f32_bf16 v18, s80, v36
v_dot2c_f32_bf16 v19, s81, v37
v_dot2c_f32_bf16 v18, s82, v38
v_dot2c_f32_bf16 v19, s83, v39
v_dot2c_f32_bf16 v18, s84, v40
v_dot2c_f32_bf16 v19, s85, v41
v_dot2c_f32_bf16 v18, s86, v42
v_dot2c_f32_bf16 v19, s87, v43
v_dot2c_f32_bf16 v18, s88, v44
v_dot2c_f32_bf16 v19, s89, v45
v_dot2c_f32_bf16 v18, s90, v46
v_dot2c_f32_bf16 v19, s91, v47
v_dot2c_f32_bf16 v18, s92, v48
v_dot2c_f32_bf16 v19, s93, v49
v_dot2c_f32_bf16 v18, s94, v50
v_dot2c_f32_bf16 v19, s95, v51
s_add_u32 s56, s29, 4
s_cmp_ge_u32 s56, 9
s_cselect_b32 s60, 9, 0
s_sub_u32 s56, s56, s60
s_add_u32 s56, s56, 0
s_lshl_b32 s56, s56, 7
s_load_dwordx16 s[64:79], s[62:63], s56
s_add_u32 s56, s56, 64
s_load_dwordx16 s[80:95], s[62:63], s56
s_nop 1
GM_nogate3:
s_waitcnt vmcnt(10)
s_barrier
s_add_u32 s56, s29, 6
s_cmp_ge_u32 s56, 9
s_cselect_b32 s60, 9, 0
s_sub_u32 s56, s56, s60
s_add_u32 s56, s56, 0
s_lshl_b32 s57, s56, 7
s_add_u32 s57, s57, s49
s_mul_i32 s58, s56, 221184
s_add_u32 s58, s58, s51
s_add_u32 s59, s57, 0
s_add_u32 m0, s50, 0
s_nop 0
buffer_load_dwordx4 v6, s[8:11], s59 offen lds
s_add_u32 s59, s57, 9216
s_add_u32 m0, s50, 1024
s_nop 0
buffer_load_dwordx4 v7, s[8:11], s59 offen lds
s_add_u32 s59, s57, 18432
s_add_u32 m0, s50, 2048
s_nop 0
buffer_load_dwordx4 v8, s[8:11], s59 offen lds
s_add_u32 s59, s57, 27648
s_add_u32 m0, s50, 3072
s_nop 0
buffer_load_dwordx4 v9, s[8:11], s59 offen lds
s_add_u32 m0, s52, 0
s_nop 0
buffer_load_dwordx4 v10, s[12:15], s58 offen lds
s_add_u32 m0, s52, 1024
s_nop 0
buffer_load_dwordx4 v11, s[12:15], s58 offen lds
s_add_u32 m0, s52, 2048
s_nop 0
buffer_load_dwordx4 v12, s[12:15], s58 offen lds
s_add_u32 m0, s52, 3072
s_nop 0
buffer_load_dwordx4 v13, s[12:15], s58 offen lds
s_add_u32 m0, s52, 4096
s_nop 0
buffer_load_dwordx4 v14, s[12:15], s58 offen lds
s_add_u32 m0, s52, 5120
s_nop 0
buffer_load_dwordx4 v15, s[12:15], s58 offen lds
s_cmp_ge_u32 s61, 2
s_cbranch_scc1 GM_nogate4
v_add_u32 v52, 16384, v16
v_xor_b32 v53, 16, v52
v_xor_b32 v54, 32, v52
v_xor_b32 v55, 48, v52
v_xor_b32 v56, 64, v52
v_xor_b32 v57, 80, v52
v_xor_b32 v58, 96, v52
v_xor_b32 v59, 112, v52
ds_read_b128 v[20:23], v52
ds_read_b128 v[24:27], v53
ds_read_b128 v[28:31], v54
ds_read_b128 v[32:35], v55
ds_read_b128 v[36:39], v56
ds_read_b128 v[40:43], v57
ds_read_b128 v[44:47], v58
ds_read_b128 v[48:51], v59
s_waitcnt lgkmcnt(0)
v_dot2c_f32_bf16 v18, s64, v20
v_dot2c_f32_bf16 v19, s65, v21
v_dot2c_f32_bf16 v18, s66, v22
v_dot2c_f32_bf16 v19, s67, v23
v_dot2c_f32_bf16 v18, s68, v24
v_dot2c_f32_bf16 v19, s69, v25
v_dot2c_f32_bf16 v18, s70, v26
v_dot2c_f32_bf16 v19, s71, v27
v_dot2c_f32_bf16 v18, s72, v28
v_dot2c_f32_bf16 v19, s73, v29
v_dot2c_f32_bf16 v18, s74, v30
v_dot2c_f32_bf16 v19, s75, v31
v_dot2c_f32_bf16 v18, s76, v32
v_dot2c_f32_bf16 v19, s77, v33
v_dot2c_f32_bf16 v18, s78, v34
v_dot2c_f32_bf16 v19, s79, v35
v_dot2c_f32_bf16 v18, s80, v36
v_dot2c_f32_bf16 v19, s81, v37
v_dot2c_f32_bf16 v18, s82, v38
v_dot2c_f32_bf16 v19, s83, v39
v_dot2c_f32_bf16 v18, s84, v40
v_dot2c_f32_bf16 v19, s85, v41
v_dot2c_f32_bf16 v18, s86, v42
v_dot2c_f32_bf16 v19, s87, v43
v_dot2c_f32_bf16 v18, s88, v44
v_dot2c_f32_bf16 v19, s89, v45
v_dot2c_f32_bf16 v18, s90, v46
v_dot2c_f32_bf16 v19, s91, v47
v_dot2c_f32_bf16 v18, s92, v48
v_dot2c_f32_bf16 v19, s93, v49
v_dot2c_f32_bf16 v18, s94, v50
v_dot2c_f32_bf16 v19, s95, v51
s_add_u32 s56, s29, 5
s_cmp_ge_u32 s56, 9
s_cselect_b32 s60, 9, 0
s_sub_u32 s56, s56, s60
s_add_u32 s56, s56, 0
s_lshl_b32 s56, s56, 7
s_load_dwordx16 s[64:79], s[62:63], s56
s_add_u32 s56, s56, 64
s_load_dwordx16 s[80:95], s[62:63], s56
s_nop 1
GM_nogate4:
s_waitcnt vmcnt(10)
s_barrier
s_add_u32 s56, s29, 7
s_cmp_ge_u32 s56, 9
s_cselect_b32 s60, 9, 0
s_sub_u32 s56, s56, s60
s_add_u32 s56, s56, 0
s_lshl_b32 s57, s56, 7
s_add_u32 s57, s57, s49
s_mul_i32 s58, s56, 221184
s_add_u32 s58, s58, s51
s_add_u32 s59, s57, 0
s_add_u32 m0, s50, 16384
s_nop 0
buffer_load_dwordx4 v6, s[8:11], s59 offen lds
s_add_u32 s59, s57, 9216
s_add_u32 m0, s50, 17408
s_nop 0
buffer_load_dwordx4 v7, s[8:11], s59 offen lds
s_add_u32 s59, s57, 18432
s_add_u32 m0, s50, 18432
s_nop 0
buffer_load_dwordx4 v8, s[8:11], s59 offen lds
s_add_u32 s59, s57, 27648
s_add_u32 m0, s50, 19456
s_nop 0
buffer_load_dwordx4 v9, s[8:11], s59 offen lds
s_add_u32 m0, s52, 24576
s_nop 0
buffer_load_dwordx4 v10, s[12:15], s58 offen lds
s_add_u32 m0, s52, 25600
s_nop 0
buffer_load_dwordx4 v11, s[12:15], s58 offen lds
s_add_u32 m0, s52, 26624
s_nop 0
buffer_load_dwordx4 v12, s[12:15], s58 offen lds
s_add_u32 m0, s52, 27648
s_nop 0
buffer_load_dwordx4 v13, s[12:15], s58 offen lds
s_add_u32 m0, s52, 28672
s_nop 0
buffer_load_dwordx4 v14, s[12:15], s58 offen lds
s_add_u32 m0, s52, 29696
s_nop 0
buffer_load_dwordx4 v15, s[12:15], s58 offen lds
s_cmp_ge_u32 s61, 2
s_cbranch_scc1 GM_nogate5
v_add_u32 v52, 32768, v16
v_xor_b32 v53, 16, v52
v_xor_b32 v54, 32, v52
v_xor_b32 v55, 48, v52
v_xor_b32 v56, 64, v52
v_xor_b32 v57, 80, v52
v_xor_b32 v58, 96, v52
v_xor_b32 v59, 112, v52
ds_read_b128 v[20:23], v52
ds_read_b128 v[24:27], v53
ds_read_b128 v[28:31], v54
ds_read_b128 v[32:35], v55
ds_read_b128 v[36:39], v56
ds_read_b128 v[40:43], v57
ds_read_b128 v[44:47], v58
ds_read_b128 v[48:51], v59
s_waitcnt lgkmcnt(0)
v_dot2c_f32_bf16 v18, s64, v20
v_dot2c_f32_bf16 v19, s65, v21
v_dot2c_f32_bf16 v18, s66, v22
v_dot2c_f32_bf16 v19, s67, v23
v_dot2c_f32_bf16 v18, s68, v24
v_dot2c_f32_bf16 v19, s69, v25
v_dot2c_f32_bf16 v18, s70, v26
v_dot2c_f32_bf16 v19, s71, v27
v_dot2c_f32_bf16 v18, s72, v28
v_dot2c_f32_bf16 v19, s73, v29
v_dot2c_f32_bf16 v18, s74, v30
v_dot2c_f32_bf16 v19, s75, v31
v_dot2c_f32_bf16 v18, s76, v32
v_dot2c_f32_bf16 v19, s77, v33
v_dot2c_f32_bf16 v18, s78, v34
v_dot2c_f32_bf16 v19, s79, v35
v_dot2c_f32_bf16 v18, s80, v36
v_dot2c_f32_bf16 v19, s81, v37
v_dot2c_f32_bf16 v18, s82, v38
v_dot2c_f32_bf16 v19, s83, v39
v_dot2c_f32_bf16 v18, s84, v40
v_dot2c_f32_bf16 v19, s85, v41
v_dot2c_f32_bf16 v18, s86, v42
v_dot2c_f32_bf16 v19, s87, v43
v_dot2c_f32_bf16 v18, s88, v44
v_dot2c_f32_bf16 v19, s89, v45
v_dot2c_f32_bf16 v18, s90, v46
v_dot2c_f32_bf16 v19, s91, v47
v_dot2c_f32_bf16 v18, s92, v48
v_dot2c_f32_bf16 v19, s93, v49
v_dot2c_f32_bf16 v18, s94, v50
v_dot2c_f32_bf16 v19, s95, v51
s_add_u32 s56, s29, 6
s_cmp_ge_u32 s56, 9
s_cselect_b32 s60, 9, 0
s_sub_u32 s56, s56, s60
s_add_u32 s56, s56, 0
s_lshl_b32 s56, s56, 7
s_load_dwordx16 s[64:79], s[62:63], s56
s_add_u32 s56, s56, 64
s_load_dwordx16 s[80:95], s[62:63], s56
s_nop 1
GM_nogate5:
s_waitcnt vmcnt(10)
s_barrier
s_add_u32 s56, s29, 8
s_cmp_ge_u32 s56, 9
s_cselect_b32 s60, 9, 0
s_sub_u32 s56, s56, s60
s_add_u32 s56, s56, 0
s_lshl_b32 s57, s56, 7
s_add_u32 s57, s57, s49
s_mul_i32 s58, s56, 221184
s_add_u32 s58, s58, s51
s_add_u32 s59, s57, 0
s_add_u32 m0, s50, 32768
s_nop 0
buffer_load_dwordx4 v6, s[8:11], s59 offen lds
s_add_u32 s59, s57, 9216
s_add_u32 m0, s50, 33792
s_nop 0
buffer_load_dwordx4 v7, s[8:11], s59 offen lds
s_add_u32 s59, s57, 18432
s_add_u32 m0, s50, 34816
s_nop 0
buffer_load_dwordx4 v8, s[8:11], s59 offen lds
s_add_u32 s59, s57, 27648
s_add_u32 m0, s50, 35840
s_nop 0
buffer_load_dwordx4 v9, s[8:11], s59 offen lds
s_add_u32 m0, s52, 49152
s_nop 0
buffer_load_dwordx4 v10, s[12:15], s58 offen lds
s_add_u32 m0, s52, 50176
s_nop 0
buffer_load_dwordx4 v11, s[12:15], s58 offen lds
s_add_u32 m0, s52, 51200
s_nop 0
buffer_load_dwordx4 v12, s[12:15], s58 offen lds
s_add_u32 m0, s52, 52224
s_nop 0
buffer_load_dwordx4 v13, s[12:15], s58 offen lds
s_add_u32 m0, s52, 53248
s_nop 0
buffer_load_dwordx4 v14, s[12:15], s58 offen lds
s_add_u32 m0, s52, 54272
s_nop 0
buffer_load_dwordx4 v15, s[12:15], s58 offen lds
s_cmp_ge_u32 s61, 2
s_cbranch_scc1 GM_nogate6
v_add_u32 v52, 0, v16
v_xor_b32 v53, 16, v52
v_xor_b32 v54, 32, v52
v_xor_b32 v55, 48, v52
v_xor_b32 v56, 64, v52
v_xor_b32 v57, 80, v52
v_xor_b32 v58, 96, v52
v_xor_b32 v59, 112, v52
ds_read_b128 v[20:23], v52
ds_read_b128 v[24:27], v53
ds_read_b128 v[28:31], v54
ds_read_b128 v[32:35], v55
ds_read_b128 v[36:39], v56
ds_read_b128 v[40:43], v57
ds_read_b128 v[44:47], v58
ds_read_b128 v[48:51], v59
s_waitcnt lgkmcnt(0)
v_dot2c_f32_bf16 v18, s64, v20
v_dot2c_f32_bf16 v19, s65, v21
v_dot2c_f32_bf16 v18, s66, v22
v_dot2c_f32_bf16 v19, s67, v23
v_dot2c_f32_bf16 v18, s68, v24
v_dot2c_f32_bf16 v19, s69, v25
v_dot2c_f32_bf16 v18, s70, v26
v_dot2c_f32_bf16 v19, s71, v27
v_dot2c_f32_bf16 v18, s72, v28
v_dot2c_f32_bf16 v19, s73, v29
v_dot2c_f32_bf16 v18, s74, v30
v_dot2c_f32_bf16 v19, s75, v31
v_dot2c_f32_bf16 v18, s76, v32
v_dot2c_f32_bf16 v19, s77, v33
v_dot2c_f32_bf16 v18, s78, v34
v_dot2c_f32_bf16 v19, s79, v35
v_dot2c_f32_bf16 v18, s80, v36
v_dot2c_f32_bf16 v19, s81, v37
v_dot2c_f32_bf16 v18, s82, v38
v_dot2c_f32_bf16 v19, s83, v39
v_dot2c_f32_bf16 v18, s84, v40
v_dot2c_f32_bf16 v19, s85, v41
v_dot2c_f32_bf16 v18, s86, v42
v_dot2c_f32_bf16 v19, s87, v43
v_dot2c_f32_bf16 v18, s88, v44
v_dot2c_f32_bf16 v19, s89, v45
v_dot2c_f32_bf16 v18, s90, v46
v_dot2c_f32_bf16 v19, s91, v47
v_dot2c_f32_bf16 v18, s92, v48
v_dot2c_f32_bf16 v19, s93, v49
v_dot2c_f32_bf16 v18, s94, v50
v_dot2c_f32_bf16 v19, s95, v51
s_add_u32 s56, s29, 7
s_cmp_ge_u32 s56, 9
s_cselect_b32 s60, 9, 0
s_sub_u32 s56, s56, s60
s_add_u32 s56, s56, 0
s_lshl_b32 s56, s56, 7
s_load_dwordx16 s[64:79], s[62:63], s56
s_add_u32 s56, s56, 64
s_load_dwordx16 s[80:95], s[62:63], s56
s_nop 1
GM_nogate6:
s_waitcnt vmcnt(10)
s_barrier
s_cmp_ge_u32 s61, 2
s_cbranch_scc1 GM_nogate7
v_add_u32 v52, 16384, v16
v_xor_b32 v53, 16, v52
v_xor_b32 v54, 32, v52
v_xor_b32 v55, 48, v52
v_xor_b32 v56, 64, v52
v_xor_b32 v57, 80, v52
v_xor_b32 v58, 96, v52
v_xor_b32 v59, 112, v52
ds_read_b128 v[20:23], v52
ds_read_b128 v[24:27], v53
ds_read_b128 v[28:31], v54
ds_read_b128 v[32:35], v55
ds_read_b128 v[36:39], v56
ds_read_b128 v[40:43], v57
ds_read_b128 v[44:47], v58
ds_read_b128 v[48:51], v59
s_waitcnt lgkmcnt(0)
v_dot2c_f32_bf16 v18, s64, v20
v_dot2c_f32_bf16 v19, s65, v21
v_dot2c_f32_bf16 v18, s66, v22
v_dot2c_f32_bf16 v19, s67, v23
v_dot2c_f32_bf16 v18, s68, v24
v_dot2c_f32_bf16 v19, s69, v25
v_dot2c_f32_bf16 v18, s70, v26
v_dot2c_f32_bf16 v19, s71, v27
v_dot2c_f32_bf16 v18, s72, v28
v_dot2c_f32_bf16 v19, s73, v29
v_dot2c_f32_bf16 v18, s74, v30
v_dot2c_f32_bf16 v19, s75, v31
v_dot2c_f32_bf16 v18, s76, v32
v_dot2c_f32_bf16 v19, s77, v33
v_dot2c_f32_bf16 v18, s78, v34
v_dot2c_f32_bf16 v19, s79, v35
v_dot2c_f32_bf16 v18, s80, v36
v_dot2c_f32_bf16 v19, s81, v37
v_dot2c_f32_bf16 v18, s82, v38
v_dot2c_f32_bf16 v19, s83, v39
v_dot2c_f32_bf16 v18, s84, v40
v_dot2c_f32_bf16 v19, s85, v41
v_dot2c_f32_bf16 v18, s86, v42
v_dot2c_f32_bf16 v19, s87, v43
v_dot2c_f32_bf16 v18, s88, v44
v_dot2c_f32_bf16 v19, s89, v45
v_dot2c_f32_bf16 v18, s90, v46
v_dot2c_f32_bf16 v19, s91, v47
v_dot2c_f32_bf16 v18, s92, v48
v_dot2c_f32_bf16 v19, s93, v49
v_dot2c_f32_bf16 v18, s94, v50
v_dot2c_f32_bf16 v19, s95, v51
s_add_u32 s56, s29, 8
s_cmp_ge_u32 s56, 9
s_cselect_b32 s60, 9, 0
s_sub_u32 s56, s56, s60
s_add_u32 s56, s56, 0
s_lshl_b32 s56, s56, 7
s_load_dwordx16 s[64:79], s[62:63], s56
s_add_u32 s56, s56, 64
s_load_dwordx16 s[80:95], s[62:63], s56
s_nop 1
GM_nogate7:
s_waitcnt vmcnt(0)
s_barrier
s_cmp_ge_u32 s61, 2
s_cbranch_scc1 GM_nogate8
v_add_u32 v52, 32768, v16
v_xor_b32 v53, 16, v52
v_xor_b32 v54, 32, v52
v_xor_b32 v55, 48, v52
v_xor_b32 v56, 64, v52
v_xor_b32 v57, 80, v52
v_xor_b32 v58, 96, v52
v_xor_b32 v59, 112, v52
ds_read_b128 v[20:23], v52
ds_read_b128 v[24:27], v53
ds_read_b128 v[28:31], v54
ds_read_b128 v[32:35], v55
ds_read_b128 v[36:39], v56
ds_read_b128 v[40:43], v57
ds_read_b128 v[44:47], v58
ds_read_b128 v[48:51], v59
s_waitcnt lgkmcnt(0)
v_dot2c_f32_bf16 v18, s64, v20
v_dot2c_f32_bf16 v19, s65, v21
v_dot2c_f32_bf16 v18, s66, v22
v_dot2c_f32_bf16 v19, s67, v23
v_dot2c_f32_bf16 v18, s68, v24
v_dot2c_f32_bf16 v19, s69, v25
v_dot2c_f32_bf16 v18, s70, v26
v_dot2c_f32_bf16 v19, s71, v27
v_dot2c_f32_bf16 v18, s72, v28
v_dot2c_f32_bf16 v19, s73, v29
v_dot2c_f32_bf16 v18, s74, v30
v_dot2c_f32_bf16 v19, s75, v31
v_dot2c_f32_bf16 v18, s76, v32
v_dot2c_f32_bf16 v19, s77, v33
v_dot2c_f32_bf16 v18, s78, v34
v_dot2c_f32_bf16 v19, s79, v35
v_dot2c_f32_bf16 v18, s80, v36
v_dot2c_f32_bf16 v19, s81, v37
v_dot2c_f32_bf16 v18, s82, v38
v_dot2c_f32_bf16 v19, s83, v39
v_dot2c_f32_bf16 v18, s84, v40
v_dot2c_f32_bf16 v19, s85, v41
v_dot2c_f32_bf16 v18, s86, v42
v_dot2c_f32_bf16 v19, s87, v43
v_dot2c_f32_bf16 v18, s88, v44
v_dot2c_f32_bf16 v19, s89, v45
v_dot2c_f32_bf16 v18, s90, v46
v_dot2c_f32_bf16 v19, s91, v47
v_dot2c_f32_bf16 v18, s92, v48
v_dot2c_f32_bf16 v19, s93, v49
v_dot2c_f32_bf16 v18, s94, v50
v_dot2c_f32_bf16 v19, s95, v51
s_nop 1
GM_nogate8:
s_cmp_ge_u32 s61, 2
s_cbranch_scc1 GM_exit
s_nop 3
v_add_f32 v18, v18, v19
v_cvt_pk_bf16_f32 v18, v18, v18
v_lshlrev_b32 v18, 16, v18
v_mul_f32 v18, 1069066811, v18
v_exp_f32 v18, -v18
s_nop 0
v_add_f32 v18, 1.0, v18
v_rcp_f32 v18, v18
s_nop 0
v_cvt_pk_bf16_f32 v18, v18, v18
v_lshlrev_b32 v18, 16, v18
v_lshlrev_b32 v2, 2, v1
s_lshl_b32 s56, s28, 9
s_lshl_b32 s60, s48, 8
s_add_u32 s56, s56, s60
s_add_u32 s56, s56, 5505024
buffer_store_dword v18, v2, s[40:43], s56 offen sc1
s_endpgm
GM_cons:
s_waitcnt lgkmcnt(0)
s_mov_b32 s8, s4
s_mov_b32 s9, s5
s_mov_b32 s10, 2359296
s_mov_b32 s11, 0x20000
s_mov_b32 s12, s6
s_mov_b32 s13, s7
s_mov_b32 s14, 1990656
s_mov_b32 s15, 0x20000
s_mov_b32 s40, s38
s_mov_b32 s41, s39
s_mov_b32 s42, 5570560
s_mov_b32 s43, 0x20000
s_mov_b32 s44, s36
s_mov_b32 s45, s37
s_mov_b32 s46, 256
s_mov_b32 s47, 0x20000
v_mov_b32 v104, 0
v_mov_b32 v105, 0
v_mov_b32 v106, 0
v_mov_b32 v107, 0
v_lshlrev_b32 v2, 4, v0
v_add_u32 v2, 122880, v2
ds_write_b128 v2, v[104:107] offset:0
ds_write_b128 v2, v[104:107] offset:4096
ds_write_b128 v2, v[104:107] offset:8192
v_cmp_gt_u32 vcc, 160, v0
s_nop 0
s_and_saveexec_b64 s[32:33], vcc
ds_write_b128 v2, v[104:107] offset:12288
s_mov_b64 exec, -1
s_and_b32 s48, s20, 1
s_lshr_b32 s49, s20, 1
v_and_b32 v6, 15, v1
v_lshrrev_b32 v7, 4, v1
v_lshrrev_b32 v2, 1, v6
v_xor_b32 v2, v2, v7
v_lshlrev_b32 v2, 4, v2
v_and_b32 v3, 12, v6
v_add_u32 v3, v3, v6
v_lshl_add_u32 v2, v3, 7, v2
s_lshl_b32 s50, s48, 13
s_add_u32 s50, s50, 0
v_add_u32 v160, s50, v2
v_xor_b32 v161, 64, v160
v_lshrrev_b32 v136, 2, v1
v_and_b32 v136, 3, v136
v_and_b32 v137, 3, v1
v_and_b32 v138, 2, v136
v_and_b32 v2, 1, v7
v_lshl_or_b32 v138, v2, 2, v138
v_lshl_add_u32 v136, v7, 3, v136
v_mul_u32_u24 v136, 384, v136
v_add_u32 v136, 49152, v136
s_mul_i32 s51, s49, 9
s_mul_i32 s52, s49, 6
s_mul_i32 s53, s49, 24
s_cmp_eq_u32 s27, 8
s_cselect_b64 s[54:55], -1, 0
v_add_u32 v2, s51, v137
v_add_u32 v3, s53, v137
v_add_u32 v3, 0, v3
v_cndmask_b32 v2, v2, v3, s[54:55]
v_lshrrev_b32 v3, 1, v2
v_xor_b32 v3, v3, v138
v_and_b32 v2, 1, v2
v_lshlrev_b32 v2, 3, v2
v_lshl_add_u32 v2, v3, 4, v2
v_add_u32 v162, v136, v2
v_add_u32 v2, s51, v137
v_add_u32 v2, 5, v2
v_add_u32 v3, s53, v137
v_add_u32 v3, 4, v3
v_cndmask_b32 v2, v2, v3, s[54:55]
v_lshrrev_b32 v3, 1, v2
v_xor_b32 v3, v3, v138
v_and_b32 v2, 1, v2
v_lshlrev_b32 v2, 3, v2
v_lshl_add_u32 v2, v3, 4, v2
v_add_u32 v163, v136, v2
v_add_u32 v2, s51, v137
v_add_u32 v2, 18, v2
v_add_u32 v3, s53, v137
v_add_u32 v3, 8, v3
v_cndmask_b32 v2, v2, v3, s[54:55]
v_lshrrev_b32 v3, 1, v2
v_xor_b32 v3, v3, v138
v_and_b32 v2, 1, v2
v_lshlrev_b32 v2, 3, v2
v_lshl_add_u32 v2, v3, 4, v2
v_add_u32 v164, v136, v2
v_add_u32 v2, s51, v137
v_add_u32 v2, 23, v2
v_add_u32 v3, s53, v137
v_add_u32 v3, 12, v3
v_cndmask_b32 v2, v2, v3, s[54:55]
v_lshrrev_b32 v3, 1, v2
v_xor_b32 v3, v3, v138
v_and_b32 v2, 1, v2
v_lshlrev_b32 v2, 3, v2
v_lshl_add_u32 v2, v3, 4, v2
v_add_u32 v165, v136, v2
v_mul_u32_u24 v2, 18, v137
v_add_u32 v2, s51, v2
v_add_u32 v2, 4, v2
v_add_u32 v3, s52, v137
v_add_u32 v3, 34, v3
v_cmp_lt_u32 vcc, 1, v137
s_nop 1
v_cndmask_b32 v2, v2, v3, vcc
v_add_u32 v3, s53, v137
v_add_u32 v3, 16, v3
v_cndmask_b32 v2, v2, v3, s[54:55]
v_lshrrev_b32 v3, 1, v2
v_xor_b32 v3, v3, v138
v_and_b32 v2, 1, v2
v_lshlrev_b32 v2, 3, v2
v_lshl_add_u32 v2, v3, 4, v2
v_add_u32 v166, v136, v2
v_add_u32 v2, s52, v137
v_add_u32 v2, 38, v2
v_add_u32 v3, s53, v137
v_add_u32 v3, 20, v3
v_cndmask_b32 v2, v2, v3, s[54:55]
v_lshrrev_b32 v3, 1, v2
v_xor_b32 v3, v3, v138
v_and_b32 v2, 1, v2
v_lshlrev_b32 v2, 3, v2
v_lshl_add_u32 v2, v3, 4, v2
v_add_u32 v167, v136, v2
v_mov_b32 v4, 0x358637bd
v_cndmask_b32 v2, 0, v4, s[54:55]
v_lshrrev_b32 v5, 2, v6
v_cmp_eq_u32 vcc, 1, v5
s_nop 1
v_cndmask_b32 v3, v4, v2, vcc
v_mov_b32 v8, v4
v_mov_b32 v9, v4
v_mov_b32 v10, v4
v_mov_b32 v11, v4
v_mov_b32 v12, v4
v_mov_b32 v13, v4
v_mov_b32 v14, v4
v_mov_b32 v15, v4
v_mov_b32 v16, v2
v_mov_b32 v17, v2
v_mov_b32 v18, v2
v_mov_b32 v19, v2
v_mov_b32 v20, v2
v_mov_b32 v21, v2
v_mov_b32 v22, v2
v_mov_b32 v23, v2
v_mov_b32 v24, v3
v_mov_b32 v25, v3
v_mov_b32 v26, v3
v_mov_b32 v27, v3
v_mov_b32 v28, v4
v_mov_b32 v29, v4
v_mov_b32 v30, v4
v_mov_b32 v31, v4
v_mov_b32 v32, v4
v_mov_b32 v33, v4
v_mov_b32 v34, v4
v_mov_b32 v35, v4
v_mov_b32 v36, v4
v_mov_b32 v37, v4
v_mov_b32 v38, v4
v_mov_b32 v39, v4
v_mov_b32 v40, v2
v_mov_b32 v41, v2
v_mov_b32 v42, v2
v_mov_b32 v43, v2
v_mov_b32 v44, v2
v_mov_b32 v45, v2
v_mov_b32 v46, v2
v_mov_b32 v47, v2
v_mov_b32 v48, v3
v_mov_b32 v49, v3
v_mov_b32 v50, v3
v_mov_b32 v51, v3
v_mov_b32 v52, v4
v_mov_b32 v53, v4
v_mov_b32 v54, v4
v_mov_b32 v55, v4
v_mov_b32 v56, v4
v_mov_b32 v57, v4
v_mov_b32 v58, v4
v_mov_b32 v59, v4
v_mov_b32 v60, v4
v_mov_b32 v61, v4
v_mov_b32 v62, v4
v_mov_b32 v63, v4
v_mov_b32 v64, v2
v_mov_b32 v65, v2
v_mov_b32 v66, v2
v_mov_b32 v67, v2
v_mov_b32 v68, v2
v_mov_b32 v69, v2
v_mov_b32 v70, v2
v_mov_b32 v71, v2
v_mov_b32 v72, v3
v_mov_b32 v73, v3
v_mov_b32 v74, v3
v_mov_b32 v75, v3
v_mov_b32 v76, v4
v_mov_b32 v77, v4
v_mov_b32 v78, v4
v_mov_b32 v79, v4
v_mov_b32 v80, v4
v_mov_b32 v81, v4
v_mov_b32 v82, v4
v_mov_b32 v83, v4
v_mov_b32 v84, v4
v_mov_b32 v85, v4
v_mov_b32 v86, v4
v_mov_b32 v87, v4
v_mov_b32 v88, v2
v_mov_b32 v89, v2
v_mov_b32 v90, v2
v_mov_b32 v91, v2
v_mov_b32 v92, v2
v_mov_b32 v93, v2
v_mov_b32 v94, v2
v_mov_b32 v95, v2
v_mov_b32 v96, v3
v_mov_b32 v97, v3
v_mov_b32 v98, v3
v_mov_b32 v99, v3
v_mov_b32 v100, v4
v_mov_b32 v101, v4
v_mov_b32 v102, v4
v_mov_b32 v103, v4
s_mov_b32 s66, 0xff0fff0f
s_mov_b32 s67, 0xff0fff0f
s_mov_b32 s68, 0xffff0000
s_mov_b32 s69, 0x0
s_mov_b32 s70, 0x0
s_mov_b32 s71, 0xffff
s_mov_b32 s72, 0x30003
s_mov_b32 s73, 0x30003
s_mov_b32 s74, 0xc000c
s_mov_b32 s75, 0xc000c
s_mov_b32 s76, 0x30000
s_mov_b32 s77, 0x0
s_mov_b32 s78, 0xc0000
s_mov_b32 s79, 0x0
s_mov_b32 s80, 0x0
s_mov_b32 s81, 0x3
s_mov_b32 s82, 0x0
s_mov_b32 s83, 0xc
s_mov_b32 s84, 0xff00ff00
s_mov_b32 s85, 0xff00ff00
s_barrier
s_waitcnt lgkmcnt(0)
s_barrier
ds_read_b128 v[104:107], v160 offset:0
ds_read_b128 v[108:111], v160 offset:512
ds_read_b128 v[112:115], v160 offset:4096
ds_read_b128 v[116:119], v160 offset:4608
ds_read_b64_tr_b16 v[136:137], v162 offset:0
ds_read_b64_tr_b16 v[138:139], v162 offset:1536
ds_read_b64_tr_b16 v[140:141], v163 offset:0
ds_read_b64_tr_b16 v[142:143], v163 offset:1536
ds_read_b64_tr_b16 v[144:145], v164 offset:0
ds_read_b64_tr_b16 v[146:147], v164 offset:1536
ds_read_b64_tr_b16 v[148:149], v165 offset:0
ds_read_b64_tr_b16 v[150:151], v165 offset:1536
ds_read_b64_tr_b16 v[152:153], v166 offset:0
ds_read_b64_tr_b16 v[154:155], v166 offset:1536
ds_read_b64_tr_b16 v[156:157], v167 offset:0
ds_read_b64_tr_b16 v[158:159], v167 offset:1536
s_waitcnt lgkmcnt(10)
v_mfma_f32_16x16x32_bf16 v[8:11], v[104:107], v[136:139], v[8:11]
v_mfma_f32_16x16x32_bf16 v[32:35], v[108:111], v[136:139], v[32:35]
v_mfma_f32_16x16x32_bf16 v[56:59], v[112:115], v[136:139], v[56:59]
v_mfma_f32_16x16x32_bf16 v[80:83], v[116:119], v[136:139], v[80:83]
s_waitcnt lgkmcnt(8)
v_mfma_f32_16x16x32_bf16 v[12:15], v[104:107], v[140:143], v[12:15]
ds_read_b64_tr_b16 v[136:137], v162 offset:12288
v_mfma_f32_16x16x32_bf16 v[36:39], v[108:111], v[140:143], v[36:39]
ds_read_b64_tr_b16 v[138:139], v162 offset:13824
v_mfma_f32_16x16x32_bf16 v[60:63], v[112:115], v[140:143], v[60:63]
ds_read_b128 v[120:123], v161 offset:0
v_mfma_f32_16x16x32_bf16 v[84:87], v[116:119], v[140:143], v[84:87]
s_waitcnt lgkmcnt(9)
v_mfma_f32_16x16x32_bf16 v[16:19], v[104:107], v[144:147], v[16:19]
ds_read_b64_tr_b16 v[140:141], v163 offset:12288
v_mfma_f32_16x16x32_bf16 v[40:43], v[108:111], v[144:147], v[40:43]
ds_read_b64_tr_b16 v[142:143], v163 offset:13824
v_mfma_f32_16x16x32_bf16 v[64:67], v[112:115], v[144:147], v[64:67]
ds_read_b128 v[124:127], v161 offset:512
v_mfma_f32_16x16x32_bf16 v[88:91], v[116:119], v[144:147], v[88:91]
s_waitcnt lgkmcnt(10)
v_mfma_f32_16x16x32_bf16 v[20:23], v[104:107], v[148:151], v[20:23]
ds_read_b64_tr_b16 v[144:145], v164 offset:12288
v_mfma_f32_16x16x32_bf16 v[44:47], v[108:111], v[148:151], v[44:47]
ds_read_b64_tr_b16 v[146:147], v164 offset:13824
v_mfma_f32_16x16x32_bf16 v[68:71], v[112:115], v[148:151], v[68:71]
ds_read_b128 v[128:131], v161 offset:4096
v_mfma_f32_16x16x32_bf16 v[92:95], v[116:119], v[148:151], v[92:95]
s_waitcnt lgkmcnt(11)
v_mfma_f32_16x16x32_bf16 v[24:27], v[104:107], v[152:155], v[24:27]
ds_read_b64_tr_b16 v[148:149], v165 offset:12288
v_mfma_f32_16x16x32_bf16 v[48:51], v[108:111], v[152:155], v[48:51]
ds_read_b64_tr_b16 v[150:151], v165 offset:13824
v_mfma_f32_16x16x32_bf16 v[72:75], v[112:115], v[152:155], v[72:75]
ds_read_b128 v[132:135], v161 offset:4608
v_mfma_f32_16x16x32_bf16 v[96:99], v[116:119], v[152:155], v[96:99]
s_waitcnt lgkmcnt(12)
v_mfma_f32_16x16x32_bf16 v[28:31], v[104:107], v[156:159], v[28:31]
ds_read_b64_tr_b16 v[152:153], v166 offset:12288
v_mfma_f32_16x16x32_bf16 v[52:55], v[108:111], v[156:159], v[52:55]
ds_read_b64_tr_b16 v[154:155], v166 offset:13824
v_mfma_f32_16x16x32_bf16 v[76:79], v[112:115], v[156:159], v[76:79]
v_mfma_f32_16x16x32_bf16 v[100:103], v[116:119], v[156:159], v[100:103]
s_waitcnt lgkmcnt(11)
v_mfma_f32_16x16x32_bf16 v[8:11], v[120:123], v[136:139], v[8:11]
ds_read_b64_tr_b16 v[156:157], v167 offset:12288
s_waitcnt lgkmcnt(9)
v_mfma_f32_16x16x32_bf16 v[32:35], v[124:127], v[136:139], v[32:35]
ds_read_b64_tr_b16 v[158:159], v167 offset:13824
s_waitcnt lgkmcnt(7)
v_mfma_f32_16x16x32_bf16 v[56:59], v[128:131], v[136:139], v[56:59]
s_waitcnt lgkmcnt(4)
v_mfma_f32_16x16x32_bf16 v[80:83], v[132:135], v[136:139], v[80:83]
v_mfma_f32_16x16x32_bf16 v[12:15], v[120:123], v[140:143], v[12:15]
v_mfma_f32_16x16x32_bf16 v[36:39], v[124:127], v[140:143], v[36:39]
v_mfma_f32_16x16x32_bf16 v[60:63], v[128:131], v[140:143], v[60:63]
v_mfma_f32_16x16x32_bf16 v[84:87], v[132:135], v[140:143], v[84:87]
s_waitcnt lgkmcnt(0)
s_barrier
v_mfma_f32_16x16x32_bf16 v[16:19], v[120:123], v[144:147], v[16:19]
ds_read_b64_tr_b16 v[136:137], v162 offset:24576
v_mfma_f32_16x16x32_bf16 v[40:43], v[124:127], v[144:147], v[40:43]
ds_read_b64_tr_b16 v[138:139], v162 offset:26112
v_mfma_f32_16x16x32_bf16 v[64:67], v[128:131], v[144:147], v[64:67]
ds_read_b128 v[104:107], v160 offset:16384
v_mfma_f32_16x16x32_bf16 v[88:91], v[132:135], v[144:147], v[88:91]
ds_read_b128 v[108:111], v160 offset:16896
v_mfma_f32_16x16x32_bf16 v[20:23], v[120:123], v[148:151], v[20:23]
ds_read_b64_tr_b16 v[140:141], v163 offset:24576
v_mfma_f32_16x16x32_bf16 v[44:47], v[124:127], v[148:151], v[44:47]
ds_read_b64_tr_b16 v[142:143], v163 offset:26112
v_mfma_f32_16x16x32_bf16 v[68:71], v[128:131], v[148:151], v[68:71]
ds_read_b128 v[112:115], v160 offset:20480
v_mfma_f32_16x16x32_bf16 v[92:95], v[132:135], v[148:151], v[92:95]
ds_read_b128 v[116:119], v160 offset:20992
v_mfma_f32_16x16x32_bf16 v[24:27], v[120:123], v[152:155], v[24:27]
ds_read_b64_tr_b16 v[144:145], v164 offset:24576
v_mfma_f32_16x16x32_bf16 v[48:51], v[124:127], v[152:155], v[48:51]
ds_read_b64_tr_b16 v[146:147], v164 offset:26112
v_mfma_f32_16x16x32_bf16 v[72:75], v[128:131], v[152:155], v[72:75]
ds_read_b64_tr_b16 v[148:149], v165 offset:24576
v_mfma_f32_16x16x32_bf16 v[96:99], v[132:135], v[152:155], v[96:99]
ds_read_b64_tr_b16 v[150:151], v165 offset:26112
v_mfma_f32_16x16x32_bf16 v[28:31], v[120:123], v[156:159], v[28:31]
ds_read_b64_tr_b16 v[152:153], v166 offset:24576
v_mfma_f32_16x16x32_bf16 v[52:55], v[124:127], v[156:159], v[52:55]
ds_read_b64_tr_b16 v[154:155], v166 offset:26112
v_mfma_f32_16x16x32_bf16 v[76:79], v[128:131], v[156:159], v[76:79]
v_mfma_f32_16x16x32_bf16 v[100:103], v[132:135], v[156:159], v[100:103]
s_waitcnt lgkmcnt(11)
v_mfma_f32_16x16x32_bf16 v[8:11], v[104:107], v[136:139], v[8:11]
ds_read_b64_tr_b16 v[156:157], v167 offset:24576
s_waitcnt lgkmcnt(11)
v_mfma_f32_16x16x32_bf16 v[32:35], v[108:111], v[136:139], v[32:35]
ds_read_b64_tr_b16 v[158:159], v167 offset:26112
s_waitcnt lgkmcnt(9)
v_mfma_f32_16x16x32_bf16 v[56:59], v[112:115], v[136:139], v[56:59]
s_waitcnt lgkmcnt(8)
v_mfma_f32_16x16x32_bf16 v[80:83], v[116:119], v[136:139], v[80:83]
v_mfma_f32_16x16x32_bf16 v[12:15], v[104:107], v[140:143], v[12:15]
ds_read_b64_tr_b16 v[136:137], v162 offset:36864
v_mfma_f32_16x16x32_bf16 v[36:39], v[108:111], v[140:143], v[36:39]
ds_read_b64_tr_b16 v[138:139], v162 offset:38400
v_mfma_f32_16x16x32_bf16 v[60:63], v[112:115], v[140:143], v[60:63]
ds_read_b128 v[120:123], v161 offset:16384
v_mfma_f32_16x16x32_bf16 v[84:87], v[116:119], v[140:143], v[84:87]
s_waitcnt lgkmcnt(9)
v_mfma_f32_16x16x32_bf16 v[16:19], v[104:107], v[144:147], v[16:19]
ds_read_b64_tr_b16 v[140:141], v163 offset:36864
v_mfma_f32_16x16x32_bf16 v[40:43], v[108:111], v[144:147], v[40:43]
ds_read_b64_tr_b16 v[142:143], v163 offset:38400
v_mfma_f32_16x16x32_bf16 v[64:67], v[112:115], v[144:147], v[64:67]
ds_read_b128 v[124:127], v161 offset:16896
v_mfma_f32_16x16x32_bf16 v[88:91], v[116:119], v[144:147], v[88:91]
s_waitcnt lgkmcnt(10)
v_mfma_f32_16x16x32_bf16 v[20:23], v[104:107], v[148:151], v[20:23]
ds_read_b64_tr_b16 v[144:145], v164 offset:36864
v_mfma_f32_16x16x32_bf16 v[44:47], v[108:111], v[148:151], v[44:47]
ds_read_b64_tr_b16 v[146:147], v164 offset:38400
v_mfma_f32_16x16x32_bf16 v[68:71], v[112:115], v[148:151], v[68:71]
ds_read_b128 v[128:131], v161 offset:20480
v_mfma_f32_16x16x32_bf16 v[92:95], v[116:119], v[148:151], v[92:95]
s_waitcnt lgkmcnt(11)
v_mfma_f32_16x16x32_bf16 v[24:27], v[104:107], v[152:155], v[24:27]
ds_read_b64_tr_b16 v[148:149], v165 offset:36864
v_mfma_f32_16x16x32_bf16 v[48:51], v[108:111], v[152:155], v[48:51]
ds_read_b64_tr_b16 v[150:151], v165 offset:38400
v_mfma_f32_16x16x32_bf16 v[72:75], v[112:115], v[152:155], v[72:75]
ds_read_b128 v[132:135], v161 offset:20992
v_mfma_f32_16x16x32_bf16 v[96:99], v[116:119], v[152:155], v[96:99]
s_waitcnt lgkmcnt(12)
v_mfma_f32_16x16x32_bf16 v[28:31], v[104:107], v[156:159], v[28:31]
ds_read_b64_tr_b16 v[152:153], v166 offset:36864
v_mfma_f32_16x16x32_bf16 v[52:55], v[108:111], v[156:159], v[52:55]
ds_read_b64_tr_b16 v[154:155], v166 offset:38400
v_mfma_f32_16x16x32_bf16 v[76:79], v[112:115], v[156:159], v[76:79]
v_mfma_f32_16x16x32_bf16 v[100:103], v[116:119], v[156:159], v[100:103]
s_waitcnt lgkmcnt(11)
v_mfma_f32_16x16x32_bf16 v[8:11], v[120:123], v[136:139], v[8:11]
ds_read_b64_tr_b16 v[156:157], v167 offset:36864
s_waitcnt lgkmcnt(9)
v_mfma_f32_16x16x32_bf16 v[32:35], v[124:127], v[136:139], v[32:35]
ds_read_b64_tr_b16 v[158:159], v167 offset:38400
s_waitcnt lgkmcnt(7)
v_mfma_f32_16x16x32_bf16 v[56:59], v[128:131], v[136:139], v[56:59]
s_waitcnt lgkmcnt(4)
v_mfma_f32_16x16x32_bf16 v[80:83], v[132:135], v[136:139], v[80:83]
v_mfma_f32_16x16x32_bf16 v[12:15], v[120:123], v[140:143], v[12:15]
v_mfma_f32_16x16x32_bf16 v[36:39], v[124:127], v[140:143], v[36:39]
v_mfma_f32_16x16x32_bf16 v[60:63], v[128:131], v[140:143], v[60:63]
v_mfma_f32_16x16x32_bf16 v[84:87], v[132:135], v[140:143], v[84:87]
s_waitcnt lgkmcnt(0)
s_barrier
v_mfma_f32_16x16x32_bf16 v[16:19], v[120:123], v[144:147], v[16:19]
ds_read_b64_tr_b16 v[136:137], v162 offset:49152
v_mfma_f32_16x16x32_bf16 v[40:43], v[124:127], v[144:147], v[40:43]
ds_read_b64_tr_b16 v[138:139], v162 offset:50688
v_mfma_f32_16x16x32_bf16 v[64:67], v[128:131], v[144:147], v[64:67]
ds_read_b128 v[104:107], v160 offset:32768
v_mfma_f32_16x16x32_bf16 v[88:91], v[132:135], v[144:147], v[88:91]
ds_read_b128 v[108:111], v160 offset:33280
v_mfma_f32_16x16x32_bf16 v[20:23], v[120:123], v[148:151], v[20:23]
ds_read_b64_tr_b16 v[140:141], v163 offset:49152
v_mfma_f32_16x16x32_bf16 v[44:47], v[124:127], v[148:151], v[44:47]
ds_read_b64_tr_b16 v[142:143], v163 offset:50688
v_mfma_f32_16x16x32_bf16 v[68:71], v[128:131], v[148:151], v[68:71]
ds_read_b128 v[112:115], v160 offset:36864
v_mfma_f32_16x16x32_bf16 v[92:95], v[132:135], v[148:151], v[92:95]
ds_read_b128 v[116:119], v160 offset:37376
v_mfma_f32_16x16x32_bf16 v[24:27], v[120:123], v[152:155], v[24:27]
ds_read_b64_tr_b16 v[144:145], v164 offset:49152
v_mfma_f32_16x16x32_bf16 v[48:51], v[124:127], v[152:155], v[48:51]
ds_read_b64_tr_b16 v[146:147], v164 offset:50688
v_mfma_f32_16x16x32_bf16 v[72:75], v[128:131], v[152:155], v[72:75]
ds_read_b64_tr_b16 v[148:149], v165 offset:49152
v_mfma_f32_16x16x32_bf16 v[96:99], v[132:135], v[152:155], v[96:99]
ds_read_b64_tr_b16 v[150:151], v165 offset:50688
v_mfma_f32_16x16x32_bf16 v[28:31], v[120:123], v[156:159], v[28:31]
ds_read_b64_tr_b16 v[152:153], v166 offset:49152
v_mfma_f32_16x16x32_bf16 v[52:55], v[124:127], v[156:159], v[52:55]
ds_read_b64_tr_b16 v[154:155], v166 offset:50688
v_mfma_f32_16x16x32_bf16 v[76:79], v[128:131], v[156:159], v[76:79]
v_mfma_f32_16x16x32_bf16 v[100:103], v[132:135], v[156:159], v[100:103]
s_waitcnt lgkmcnt(11)
v_mfma_f32_16x16x32_bf16 v[8:11], v[104:107], v[136:139], v[8:11]
ds_read_b64_tr_b16 v[156:157], v167 offset:49152
s_waitcnt lgkmcnt(11)
v_mfma_f32_16x16x32_bf16 v[32:35], v[108:111], v[136:139], v[32:35]
ds_read_b64_tr_b16 v[158:159], v167 offset:50688
s_waitcnt lgkmcnt(9)
v_mfma_f32_16x16x32_bf16 v[56:59], v[112:115], v[136:139], v[56:59]
s_waitcnt lgkmcnt(8)
v_mfma_f32_16x16x32_bf16 v[80:83], v[116:119], v[136:139], v[80:83]
v_mfma_f32_16x16x32_bf16 v[12:15], v[104:107], v[140:143], v[12:15]
ds_read_b64_tr_b16 v[136:137], v162 offset:61440
v_mfma_f32_16x16x32_bf16 v[36:39], v[108:111], v[140:143], v[36:39]
ds_read_b64_tr_b16 v[138:139], v162 offset:62976
v_mfma_f32_16x16x32_bf16 v[60:63], v[112:115], v[140:143], v[60:63]
ds_read_b128 v[120:123], v161 offset:32768
v_mfma_f32_16x16x32_bf16 v[84:87], v[116:119], v[140:143], v[84:87]
s_waitcnt lgkmcnt(9)
v_mfma_f32_16x16x32_bf16 v[16:19], v[104:107], v[144:147], v[16:19]
ds_read_b64_tr_b16 v[140:141], v163 offset:61440
v_mfma_f32_16x16x32_bf16 v[40:43], v[108:111], v[144:147], v[40:43]
ds_read_b64_tr_b16 v[142:143], v163 offset:62976
v_mfma_f32_16x16x32_bf16 v[64:67], v[112:115], v[144:147], v[64:67]
ds_read_b128 v[124:127], v161 offset:33280
v_mfma_f32_16x16x32_bf16 v[88:91], v[116:119], v[144:147], v[88:91]
s_waitcnt lgkmcnt(10)
v_mfma_f32_16x16x32_bf16 v[20:23], v[104:107], v[148:151], v[20:23]
ds_read_b64_tr_b16 v[144:145], v164 offset:61440
v_mfma_f32_16x16x32_bf16 v[44:47], v[108:111], v[148:151], v[44:47]
ds_read_b64_tr_b16 v[146:147], v164 offset:62976
v_mfma_f32_16x16x32_bf16 v[68:71], v[112:115], v[148:151], v[68:71]
ds_read_b128 v[128:131], v161 offset:36864
v_mfma_f32_16x16x32_bf16 v[92:95], v[116:119], v[148:151], v[92:95]
s_waitcnt lgkmcnt(11)
v_mfma_f32_16x16x32_bf16 v[24:27], v[104:107], v[152:155], v[24:27]
ds_read_b64_tr_b16 v[148:149], v165 offset:61440
v_mfma_f32_16x16x32_bf16 v[48:51], v[108:111], v[152:155], v[48:51]
ds_read_b64_tr_b16 v[150:151], v165 offset:62976
v_mfma_f32_16x16x32_bf16 v[72:75], v[112:115], v[152:155], v[72:75]
ds_read_b128 v[132:135], v161 offset:37376
v_mfma_f32_16x16x32_bf16 v[96:99], v[116:119], v[152:155], v[96:99]
s_waitcnt lgkmcnt(12)
v_mfma_f32_16x16x32_bf16 v[28:31], v[104:107], v[156:159], v[28:31]
ds_read_b64_tr_b16 v[152:153], v166 offset:61440
v_mfma_f32_16x16x32_bf16 v[52:55], v[108:111], v[156:159], v[52:55]
ds_read_b64_tr_b16 v[154:155], v166 offset:62976
v_mfma_f32_16x16x32_bf16 v[76:79], v[112:115], v[156:159], v[76:79]
v_mfma_f32_16x16x32_bf16 v[100:103], v[116:119], v[156:159], v[100:103]
s_waitcnt lgkmcnt(11)
v_mfma_f32_16x16x32_bf16 v[8:11], v[120:123], v[136:139], v[8:11]
ds_read_b64_tr_b16 v[156:157], v167 offset:61440
s_waitcnt lgkmcnt(9)
v_mfma_f32_16x16x32_bf16 v[32:35], v[124:127], v[136:139], v[32:35]
ds_read_b64_tr_b16 v[158:159], v167 offset:62976
s_waitcnt lgkmcnt(7)
v_mfma_f32_16x16x32_bf16 v[56:59], v[128:131], v[136:139], v[56:59]
s_waitcnt lgkmcnt(4)
v_mfma_f32_16x16x32_bf16 v[80:83], v[132:135], v[136:139], v[80:83]
v_mfma_f32_16x16x32_bf16 v[12:15], v[120:123], v[140:143], v[12:15]
v_mfma_f32_16x16x32_bf16 v[36:39], v[124:127], v[140:143], v[36:39]
v_mfma_f32_16x16x32_bf16 v[60:63], v[128:131], v[140:143], v[60:63]
v_mfma_f32_16x16x32_bf16 v[84:87], v[132:135], v[140:143], v[84:87]
s_waitcnt lgkmcnt(0)
s_barrier
v_mfma_f32_16x16x32_bf16 v[16:19], v[120:123], v[144:147], v[16:19]
ds_read_b64_tr_b16 v[136:137], v162 offset:0
v_mfma_f32_16x16x32_bf16 v[40:43], v[124:127], v[144:147], v[40:43]
ds_read_b64_tr_b16 v[138:139], v162 offset:1536
v_mfma_f32_16x16x32_bf16 v[64:67], v[128:131], v[144:147], v[64:67]
ds_read_b128 v[104:107], v160 offset:0
v_mfma_f32_16x16x32_bf16 v[88:91], v[132:135], v[144:147], v[88:91]
ds_read_b128 v[108:111], v160 offset:512
v_mfma_f32_16x16x32_bf16 v[20:23], v[120:123], v[148:151], v[20:23]
ds_read_b64_tr_b16 v[140:141], v163 offset:0
v_mfma_f32_16x16x32_bf16 v[44:47], v[124:127], v[148:151], v[44:47]
ds_read_b64_tr_b16 v[142:143], v163 offset:1536
v_mfma_f32_16x16x32_bf16 v[68:71], v[128:131], v[148:151], v[68:71]
ds_read_b128 v[112:115], v160 offset:4096
v_mfma_f32_16x16x32_bf16 v[92:95], v[132:135], v[148:151], v[92:95]
ds_read_b128 v[116:119], v160 offset:4608
v_mfma_f32_16x16x32_bf16 v[24:27], v[120:123], v[152:155], v[24:27]
ds_read_b64_tr_b16 v[144:145], v164 offset:0
v_mfma_f32_16x16x32_bf16 v[48:51], v[124:127], v[152:155], v[48:51]
ds_read_b64_tr_b16 v[146:147], v164 offset:1536
v_mfma_f32_16x16x32_bf16 v[72:75], v[128:131], v[152:155], v[72:75]
ds_read_b64_tr_b16 v[148:149], v165 offset:0
v_mfma_f32_16x16x32_bf16 v[96:99], v[132:135], v[152:155], v[96:99]
ds_read_b64_tr_b16 v[150:151], v165 offset:1536
v_mfma_f32_16x16x32_bf16 v[28:31], v[120:123], v[156:159], v[28:31]
ds_read_b64_tr_b16 v[152:153], v166 offset:0
v_mfma_f32_16x16x32_bf16 v[52:55], v[124:127], v[156:159], v[52:55]
ds_read_b64_tr_b16 v[154:155], v166 offset:1536
v_mfma_f32_16x16x32_bf16 v[76:79], v[128:131], v[156:159], v[76:79]
v_mfma_f32_16x16x32_bf16 v[100:103], v[132:135], v[156:159], v[100:103]
s_waitcnt lgkmcnt(11)
v_mfma_f32_16x16x32_bf16 v[8:11], v[104:107], v[136:139], v[8:11]
ds_read_b64_tr_b16 v[156:157], v167 offset:0
s_waitcnt lgkmcnt(11)
v_mfma_f32_16x16x32_bf16 v[32:35], v[108:111], v[136:139], v[32:35]
ds_read_b64_tr_b16 v[158:159], v167 offset:1536
s_waitcnt lgkmcnt(9)
v_mfma_f32_16x16x32_bf16 v[56:59], v[112:115], v[136:139], v[56:59]
s_waitcnt lgkmcnt(8)
v_mfma_f32_16x16x32_bf16 v[80:83], v[116:119], v[136:139], v[80:83]
v_mfma_f32_16x16x32_bf16 v[12:15], v[104:107], v[140:143], v[12:15]
ds_read_b64_tr_b16 v[136:137], v162 offset:12288
v_mfma_f32_16x16x32_bf16 v[36:39], v[108:111], v[140:143], v[36:39]
ds_read_b64_tr_b16 v[138:139], v162 offset:13824
v_mfma_f32_16x16x32_bf16 v[60:63], v[112:115], v[140:143], v[60:63]
ds_read_b128 v[120:123], v161 offset:0
v_mfma_f32_16x16x32_bf16 v[84:87], v[116:119], v[140:143], v[84:87]
s_waitcnt lgkmcnt(9)
v_mfma_f32_16x16x32_bf16 v[16:19], v[104:107], v[144:147], v[16:19]
ds_read_b64_tr_b16 v[140:141], v163 offset:12288
v_mfma_f32_16x16x32_bf16 v[40:43], v[108:111], v[144:147], v[40:43]
ds_read_b64_tr_b16 v[142:143], v163 offset:13824
v_mfma_f32_16x16x32_bf16 v[64:67], v[112:115], v[144:147], v[64:67]
ds_read_b128 v[124:127], v161 offset:512
v_mfma_f32_16x16x32_bf16 v[88:91], v[116:119], v[144:147], v[88:91]
s_waitcnt lgkmcnt(10)
v_mfma_f32_16x16x32_bf16 v[20:23], v[104:107], v[148:151], v[20:23]
ds_read_b64_tr_b16 v[144:145], v164 offset:12288
v_mfma_f32_16x16x32_bf16 v[44:47], v[108:111], v[148:151], v[44:47]
ds_read_b64_tr_b16 v[146:147], v164 offset:13824
v_mfma_f32_16x16x32_bf16 v[68:71], v[112:115], v[148:151], v[68:71]
ds_read_b128 v[128:131], v161 offset:4096
v_mfma_f32_16x16x32_bf16 v[92:95], v[116:119], v[148:151], v[92:95]
s_waitcnt lgkmcnt(11)
v_mfma_f32_16x16x32_bf16 v[24:27], v[104:107], v[152:155], v[24:27]
ds_read_b64_tr_b16 v[148:149], v165 offset:12288
v_mfma_f32_16x16x32_bf16 v[48:51], v[108:111], v[152:155], v[48:51]
ds_read_b64_tr_b16 v[150:151], v165 offset:13824
v_mfma_f32_16x16x32_bf16 v[72:75], v[112:115], v[152:155], v[72:75]
ds_read_b128 v[132:135], v161 offset:4608
v_mfma_f32_16x16x32_bf16 v[96:99], v[116:119], v[152:155], v[96:99]
s_waitcnt lgkmcnt(12)
v_mfma_f32_16x16x32_bf16 v[28:31], v[104:107], v[156:159], v[28:31]
ds_read_b64_tr_b16 v[152:153], v166 offset:12288
v_mfma_f32_16x16x32_bf16 v[52:55], v[108:111], v[156:159], v[52:55]
ds_read_b64_tr_b16 v[154:155], v166 offset:13824
v_mfma_f32_16x16x32_bf16 v[76:79], v[112:115], v[156:159], v[76:79]
v_mfma_f32_16x16x32_bf16 v[100:103], v[116:119], v[156:159], v[100:103]
s_waitcnt lgkmcnt(11)
v_mfma_f32_16x16x32_bf16 v[8:11], v[120:123], v[136:139], v[8:11]
ds_read_b64_tr_b16 v[156:157], v167 offset:12288
s_waitcnt lgkmcnt(9)
v_mfma_f32_16x16x32_bf16 v[32:35], v[124:127], v[136:139], v[32:35]
ds_read_b64_tr_b16 v[158:159], v167 offset:13824
s_waitcnt lgkmcnt(7)
v_mfma_f32_16x16x32_bf16 v[56:59], v[128:131], v[136:139], v[56:59]
s_waitcnt lgkmcnt(4)
v_mfma_f32_16x16x32_bf16 v[80:83], v[132:135], v[136:139], v[80:83]
v_mfma_f32_16x16x32_bf16 v[12:15], v[120:123], v[140:143], v[12:15]
v_mfma_f32_16x16x32_bf16 v[36:39], v[124:127], v[140:143], v[36:39]
v_mfma_f32_16x16x32_bf16 v[60:63], v[128:131], v[140:143], v[60:63]
v_mfma_f32_16x16x32_bf16 v[84:87], v[132:135], v[140:143], v[84:87]
s_waitcnt lgkmcnt(0)
s_barrier
v_mfma_f32_16x16x32_bf16 v[16:19], v[120:123], v[144:147], v[16:19]
ds_read_b64_tr_b16 v[136:137], v162 offset:24576
v_mfma_f32_16x16x32_bf16 v[40:43], v[124:127], v[144:147], v[40:43]
ds_read_b64_tr_b16 v[138:139], v162 offset:26112
v_mfma_f32_16x16x32_bf16 v[64:67], v[128:131], v[144:147], v[64:67]
ds_read_b128 v[104:107], v160 offset:16384
v_mfma_f32_16x16x32_bf16 v[88:91], v[132:135], v[144:147], v[88:91]
ds_read_b128 v[108:111], v160 offset:16896
v_mfma_f32_16x16x32_bf16 v[20:23], v[120:123], v[148:151], v[20:23]
ds_read_b64_tr_b16 v[140:141], v163 offset:24576
v_mfma_f32_16x16x32_bf16 v[44:47], v[124:127], v[148:151], v[44:47]
ds_read_b64_tr_b16 v[142:143], v163 offset:26112
v_mfma_f32_16x16x32_bf16 v[68:71], v[128:131], v[148:151], v[68:71]
ds_read_b128 v[112:115], v160 offset:20480
v_mfma_f32_16x16x32_bf16 v[92:95], v[132:135], v[148:151], v[92:95]
ds_read_b128 v[116:119], v160 offset:20992
v_mfma_f32_16x16x32_bf16 v[24:27], v[120:123], v[152:155], v[24:27]
ds_read_b64_tr_b16 v[144:145], v164 offset:24576
v_mfma_f32_16x16x32_bf16 v[48:51], v[124:127], v[152:155], v[48:51]
ds_read_b64_tr_b16 v[146:147], v164 offset:26112
v_mfma_f32_16x16x32_bf16 v[72:75], v[128:131], v[152:155], v[72:75]
ds_read_b64_tr_b16 v[148:149], v165 offset:24576
v_mfma_f32_16x16x32_bf16 v[96:99], v[132:135], v[152:155], v[96:99]
ds_read_b64_tr_b16 v[150:151], v165 offset:26112
v_mfma_f32_16x16x32_bf16 v[28:31], v[120:123], v[156:159], v[28:31]
ds_read_b64_tr_b16 v[152:153], v166 offset:24576
v_mfma_f32_16x16x32_bf16 v[52:55], v[124:127], v[156:159], v[52:55]
ds_read_b64_tr_b16 v[154:155], v166 offset:26112
v_mfma_f32_16x16x32_bf16 v[76:79], v[128:131], v[156:159], v[76:79]
v_mfma_f32_16x16x32_bf16 v[100:103], v[132:135], v[156:159], v[100:103]
s_waitcnt lgkmcnt(11)
v_mfma_f32_16x16x32_bf16 v[8:11], v[104:107], v[136:139], v[8:11]
ds_read_b64_tr_b16 v[156:157], v167 offset:24576
s_waitcnt lgkmcnt(11)
v_mfma_f32_16x16x32_bf16 v[32:35], v[108:111], v[136:139], v[32:35]
ds_read_b64_tr_b16 v[158:159], v167 offset:26112
s_waitcnt lgkmcnt(9)
v_mfma_f32_16x16x32_bf16 v[56:59], v[112:115], v[136:139], v[56:59]
s_waitcnt lgkmcnt(8)
v_mfma_f32_16x16x32_bf16 v[80:83], v[116:119], v[136:139], v[80:83]
v_mfma_f32_16x16x32_bf16 v[12:15], v[104:107], v[140:143], v[12:15]
ds_read_b64_tr_b16 v[136:137], v162 offset:36864
v_mfma_f32_16x16x32_bf16 v[36:39], v[108:111], v[140:143], v[36:39]
ds_read_b64_tr_b16 v[138:139], v162 offset:38400
v_mfma_f32_16x16x32_bf16 v[60:63], v[112:115], v[140:143], v[60:63]
ds_read_b128 v[120:123], v161 offset:16384
v_mfma_f32_16x16x32_bf16 v[84:87], v[116:119], v[140:143], v[84:87]
s_waitcnt lgkmcnt(9)
v_mfma_f32_16x16x32_bf16 v[16:19], v[104:107], v[144:147], v[16:19]
ds_read_b64_tr_b16 v[140:141], v163 offset:36864
v_mfma_f32_16x16x32_bf16 v[40:43], v[108:111], v[144:147], v[40:43]
ds_read_b64_tr_b16 v[142:143], v163 offset:38400
v_mfma_f32_16x16x32_bf16 v[64:67], v[112:115], v[144:147], v[64:67]
ds_read_b128 v[124:127], v161 offset:16896
v_mfma_f32_16x16x32_bf16 v[88:91], v[116:119], v[144:147], v[88:91]
s_waitcnt lgkmcnt(10)
v_mfma_f32_16x16x32_bf16 v[20:23], v[104:107], v[148:151], v[20:23]
ds_read_b64_tr_b16 v[144:145], v164 offset:36864
v_mfma_f32_16x16x32_bf16 v[44:47], v[108:111], v[148:151], v[44:47]
ds_read_b64_tr_b16 v[146:147], v164 offset:38400
v_mfma_f32_16x16x32_bf16 v[68:71], v[112:115], v[148:151], v[68:71]
ds_read_b128 v[128:131], v161 offset:20480
v_mfma_f32_16x16x32_bf16 v[92:95], v[116:119], v[148:151], v[92:95]
s_waitcnt lgkmcnt(11)
v_mfma_f32_16x16x32_bf16 v[24:27], v[104:107], v[152:155], v[24:27]
ds_read_b64_tr_b16 v[148:149], v165 offset:36864
v_mfma_f32_16x16x32_bf16 v[48:51], v[108:111], v[152:155], v[48:51]
ds_read_b64_tr_b16 v[150:151], v165 offset:38400
v_mfma_f32_16x16x32_bf16 v[72:75], v[112:115], v[152:155], v[72:75]
ds_read_b128 v[132:135], v161 offset:20992
v_mfma_f32_16x16x32_bf16 v[96:99], v[116:119], v[152:155], v[96:99]
s_waitcnt lgkmcnt(12)
v_mfma_f32_16x16x32_bf16 v[28:31], v[104:107], v[156:159], v[28:31]
ds_read_b64_tr_b16 v[152:153], v166 offset:36864
v_mfma_f32_16x16x32_bf16 v[52:55], v[108:111], v[156:159], v[52:55]
ds_read_b64_tr_b16 v[154:155], v166 offset:38400
v_mfma_f32_16x16x32_bf16 v[76:79], v[112:115], v[156:159], v[76:79]
v_mfma_f32_16x16x32_bf16 v[100:103], v[116:119], v[156:159], v[100:103]
s_waitcnt lgkmcnt(11)
v_mfma_f32_16x16x32_bf16 v[8:11], v[120:123], v[136:139], v[8:11]
ds_read_b64_tr_b16 v[156:157], v167 offset:36864
s_waitcnt lgkmcnt(9)
v_mfma_f32_16x16x32_bf16 v[32:35], v[124:127], v[136:139], v[32:35]
ds_read_b64_tr_b16 v[158:159], v167 offset:38400
s_waitcnt lgkmcnt(7)
v_mfma_f32_16x16x32_bf16 v[56:59], v[128:131], v[136:139], v[56:59]
s_waitcnt lgkmcnt(4)
v_mfma_f32_16x16x32_bf16 v[80:83], v[132:135], v[136:139], v[80:83]
v_mfma_f32_16x16x32_bf16 v[12:15], v[120:123], v[140:143], v[12:15]
v_mfma_f32_16x16x32_bf16 v[36:39], v[124:127], v[140:143], v[36:39]
v_mfma_f32_16x16x32_bf16 v[60:63], v[128:131], v[140:143], v[60:63]
v_mfma_f32_16x16x32_bf16 v[84:87], v[132:135], v[140:143], v[84:87]
s_waitcnt lgkmcnt(0)
s_barrier
v_mfma_f32_16x16x32_bf16 v[16:19], v[120:123], v[144:147], v[16:19]
ds_read_b64_tr_b16 v[136:137], v162 offset:49152
v_mfma_f32_16x16x32_bf16 v[40:43], v[124:127], v[144:147], v[40:43]
ds_read_b64_tr_b16 v[138:139], v162 offset:50688
v_mfma_f32_16x16x32_bf16 v[64:67], v[128:131], v[144:147], v[64:67]
ds_read_b128 v[104:107], v160 offset:32768
v_mfma_f32_16x16x32_bf16 v[88:91], v[132:135], v[144:147], v[88:91]
ds_read_b128 v[108:111], v160 offset:33280
v_mfma_f32_16x16x32_bf16 v[20:23], v[120:123], v[148:151], v[20:23]
ds_read_b64_tr_b16 v[140:141], v163 offset:49152
v_mfma_f32_16x16x32_bf16 v[44:47], v[124:127], v[148:151], v[44:47]
ds_read_b64_tr_b16 v[142:143], v163 offset:50688
v_mfma_f32_16x16x32_bf16 v[68:71], v[128:131], v[148:151], v[68:71]
ds_read_b128 v[112:115], v160 offset:36864
v_mfma_f32_16x16x32_bf16 v[92:95], v[132:135], v[148:151], v[92:95]
ds_read_b128 v[116:119], v160 offset:37376
v_mfma_f32_16x16x32_bf16 v[24:27], v[120:123], v[152:155], v[24:27]
ds_read_b64_tr_b16 v[144:145], v164 offset:49152
v_mfma_f32_16x16x32_bf16 v[48:51], v[124:127], v[152:155], v[48:51]
ds_read_b64_tr_b16 v[146:147], v164 offset:50688
v_mfma_f32_16x16x32_bf16 v[72:75], v[128:131], v[152:155], v[72:75]
ds_read_b64_tr_b16 v[148:149], v165 offset:49152
v_mfma_f32_16x16x32_bf16 v[96:99], v[132:135], v[152:155], v[96:99]
ds_read_b64_tr_b16 v[150:151], v165 offset:50688
v_mfma_f32_16x16x32_bf16 v[28:31], v[120:123], v[156:159], v[28:31]
ds_read_b64_tr_b16 v[152:153], v166 offset:49152
v_mfma_f32_16x16x32_bf16 v[52:55], v[124:127], v[156:159], v[52:55]
ds_read_b64_tr_b16 v[154:155], v166 offset:50688
v_mfma_f32_16x16x32_bf16 v[76:79], v[128:131], v[156:159], v[76:79]
v_mfma_f32_16x16x32_bf16 v[100:103], v[132:135], v[156:159], v[100:103]
s_waitcnt lgkmcnt(11)
v_mfma_f32_16x16x32_bf16 v[8:11], v[104:107], v[136:139], v[8:11]
ds_read_b64_tr_b16 v[156:157], v167 offset:49152
s_waitcnt lgkmcnt(11)
v_mfma_f32_16x16x32_bf16 v[32:35], v[108:111], v[136:139], v[32:35]
ds_read_b64_tr_b16 v[158:159], v167 offset:50688
s_waitcnt lgkmcnt(9)
v_mfma_f32_16x16x32_bf16 v[56:59], v[112:115], v[136:139], v[56:59]
s_waitcnt lgkmcnt(8)
v_mfma_f32_16x16x32_bf16 v[80:83], v[116:119], v[136:139], v[80:83]
v_mfma_f32_16x16x32_bf16 v[12:15], v[104:107], v[140:143], v[12:15]
ds_read_b64_tr_b16 v[136:137], v162 offset:61440
v_mfma_f32_16x16x32_bf16 v[36:39], v[108:111], v[140:143], v[36:39]
ds_read_b64_tr_b16 v[138:139], v162 offset:62976
v_mfma_f32_16x16x32_bf16 v[60:63], v[112:115], v[140:143], v[60:63]
ds_read_b128 v[120:123], v161 offset:32768
v_mfma_f32_16x16x32_bf16 v[84:87], v[116:119], v[140:143], v[84:87]
s_waitcnt lgkmcnt(9)
v_mfma_f32_16x16x32_bf16 v[16:19], v[104:107], v[144:147], v[16:19]
ds_read_b64_tr_b16 v[140:141], v163 offset:61440
v_mfma_f32_16x16x32_bf16 v[40:43], v[108:111], v[144:147], v[40:43]
ds_read_b64_tr_b16 v[142:143], v163 offset:62976
v_mfma_f32_16x16x32_bf16 v[64:67], v[112:115], v[144:147], v[64:67]
ds_read_b128 v[124:127], v161 offset:33280
v_mfma_f32_16x16x32_bf16 v[88:91], v[116:119], v[144:147], v[88:91]
s_waitcnt lgkmcnt(10)
v_mfma_f32_16x16x32_bf16 v[20:23], v[104:107], v[148:151], v[20:23]
ds_read_b64_tr_b16 v[144:145], v164 offset:61440
v_mfma_f32_16x16x32_bf16 v[44:47], v[108:111], v[148:151], v[44:47]
ds_read_b64_tr_b16 v[146:147], v164 offset:62976
v_mfma_f32_16x16x32_bf16 v[68:71], v[112:115], v[148:151], v[68:71]
ds_read_b128 v[128:131], v161 offset:36864
v_mfma_f32_16x16x32_bf16 v[92:95], v[116:119], v[148:151], v[92:95]
s_waitcnt lgkmcnt(11)
v_mfma_f32_16x16x32_bf16 v[24:27], v[104:107], v[152:155], v[24:27]
ds_read_b64_tr_b16 v[148:149], v165 offset:61440
v_mfma_f32_16x16x32_bf16 v[48:51], v[108:111], v[152:155], v[48:51]
ds_read_b64_tr_b16 v[150:151], v165 offset:62976
v_mfma_f32_16x16x32_bf16 v[72:75], v[112:115], v[152:155], v[72:75]
ds_read_b128 v[132:135], v161 offset:37376
v_mfma_f32_16x16x32_bf16 v[96:99], v[116:119], v[152:155], v[96:99]
s_waitcnt lgkmcnt(12)
v_mfma_f32_16x16x32_bf16 v[28:31], v[104:107], v[156:159], v[28:31]
ds_read_b64_tr_b16 v[152:153], v166 offset:61440
v_mfma_f32_16x16x32_bf16 v[52:55], v[108:111], v[156:159], v[52:55]
ds_read_b64_tr_b16 v[154:155], v166 offset:62976
v_mfma_f32_16x16x32_bf16 v[76:79], v[112:115], v[156:159], v[76:79]
v_mfma_f32_16x16x32_bf16 v[100:103], v[116:119], v[156:159], v[100:103]
s_waitcnt lgkmcnt(11)
v_mfma_f32_16x16x32_bf16 v[8:11], v[120:123], v[136:139], v[8:11]
ds_read_b64_tr_b16 v[156:157], v167 offset:61440
s_waitcnt lgkmcnt(9)
v_mfma_f32_16x16x32_bf16 v[32:35], v[124:127], v[136:139], v[32:35]
ds_read_b64_tr_b16 v[158:159], v167 offset:62976
s_waitcnt lgkmcnt(7)
v_mfma_f32_16x16x32_bf16 v[56:59], v[128:131], v[136:139], v[56:59]
s_waitcnt lgkmcnt(4)
v_mfma_f32_16x16x32_bf16 v[80:83], v[132:135], v[136:139], v[80:83]
v_mfma_f32_16x16x32_bf16 v[12:15], v[120:123], v[140:143], v[12:15]
v_mfma_f32_16x16x32_bf16 v[36:39], v[124:127], v[140:143], v[36:39]
v_mfma_f32_16x16x32_bf16 v[60:63], v[128:131], v[140:143], v[60:63]
v_mfma_f32_16x16x32_bf16 v[84:87], v[132:135], v[140:143], v[84:87]
s_waitcnt lgkmcnt(0)
s_barrier
v_mfma_f32_16x16x32_bf16 v[16:19], v[120:123], v[144:147], v[16:19]
ds_read_b64_tr_b16 v[136:137], v162 offset:0
v_mfma_f32_16x16x32_bf16 v[40:43], v[124:127], v[144:147], v[40:43]
ds_read_b64_tr_b16 v[138:139], v162 offset:1536
v_mfma_f32_16x16x32_bf16 v[64:67], v[128:131], v[144:147], v[64:67]
ds_read_b128 v[104:107], v160 offset:0
v_mfma_f32_16x16x32_bf16 v[88:91], v[132:135], v[144:147], v[88:91]
ds_read_b128 v[108:111], v160 offset:512
v_mfma_f32_16x16x32_bf16 v[20:23], v[120:123], v[148:151], v[20:23]
ds_read_b64_tr_b16 v[140:141], v163 offset:0
v_mfma_f32_16x16x32_bf16 v[44:47], v[124:127], v[148:151], v[44:47]
ds_read_b64_tr_b16 v[142:143], v163 offset:1536
v_mfma_f32_16x16x32_bf16 v[68:71], v[128:131], v[148:151], v[68:71]
ds_read_b128 v[112:115], v160 offset:4096
v_mfma_f32_16x16x32_bf16 v[92:95], v[132:135], v[148:151], v[92:95]
ds_read_b128 v[116:119], v160 offset:4608
v_mfma_f32_16x16x32_bf16 v[24:27], v[120:123], v[152:155], v[24:27]
ds_read_b64_tr_b16 v[144:145], v164 offset:0
v_mfma_f32_16x16x32_bf16 v[48:51], v[124:127], v[152:155], v[48:51]
ds_read_b64_tr_b16 v[146:147], v164 offset:1536
v_mfma_f32_16x16x32_bf16 v[72:75], v[128:131], v[152:155], v[72:75]
ds_read_b64_tr_b16 v[148:149], v165 offset:0
v_mfma_f32_16x16x32_bf16 v[96:99], v[132:135], v[152:155], v[96:99]
ds_read_b64_tr_b16 v[150:151], v165 offset:1536
v_mfma_f32_16x16x32_bf16 v[28:31], v[120:123], v[156:159], v[28:31]
ds_read_b64_tr_b16 v[152:153], v166 offset:0
v_mfma_f32_16x16x32_bf16 v[52:55], v[124:127], v[156:159], v[52:55]
ds_read_b64_tr_b16 v[154:155], v166 offset:1536
v_mfma_f32_16x16x32_bf16 v[76:79], v[128:131], v[156:159], v[76:79]
v_mfma_f32_16x16x32_bf16 v[100:103], v[132:135], v[156:159], v[100:103]
s_waitcnt lgkmcnt(11)
v_mfma_f32_16x16x32_bf16 v[8:11], v[104:107], v[136:139], v[8:11]
ds_read_b64_tr_b16 v[156:157], v167 offset:0
s_waitcnt lgkmcnt(11)
v_mfma_f32_16x16x32_bf16 v[32:35], v[108:111], v[136:139], v[32:35]
ds_read_b64_tr_b16 v[158:159], v167 offset:1536
s_waitcnt lgkmcnt(9)
v_mfma_f32_16x16x32_bf16 v[56:59], v[112:115], v[136:139], v[56:59]
s_waitcnt lgkmcnt(8)
v_mfma_f32_16x16x32_bf16 v[80:83], v[116:119], v[136:139], v[80:83]
v_mfma_f32_16x16x32_bf16 v[12:15], v[104:107], v[140:143], v[12:15]
ds_read_b64_tr_b16 v[136:137], v162 offset:12288
v_mfma_f32_16x16x32_bf16 v[36:39], v[108:111], v[140:143], v[36:39]
ds_read_b64_tr_b16 v[138:139], v162 offset:13824
v_mfma_f32_16x16x32_bf16 v[60:63], v[112:115], v[140:143], v[60:63]
ds_read_b128 v[120:123], v161 offset:0
v_mfma_f32_16x16x32_bf16 v[84:87], v[116:119], v[140:143], v[84:87]
s_waitcnt lgkmcnt(9)
v_mfma_f32_16x16x32_bf16 v[16:19], v[104:107], v[144:147], v[16:19]
ds_read_b64_tr_b16 v[140:141], v163 offset:12288
v_mfma_f32_16x16x32_bf16 v[40:43], v[108:111], v[144:147], v[40:43]
ds_read_b64_tr_b16 v[142:143], v163 offset:13824
v_mfma_f32_16x16x32_bf16 v[64:67], v[112:115], v[144:147], v[64:67]
ds_read_b128 v[124:127], v161 offset:512
v_mfma_f32_16x16x32_bf16 v[88:91], v[116:119], v[144:147], v[88:91]
s_waitcnt lgkmcnt(10)
v_mfma_f32_16x16x32_bf16 v[20:23], v[104:107], v[148:151], v[20:23]
ds_read_b64_tr_b16 v[144:145], v164 offset:12288
v_mfma_f32_16x16x32_bf16 v[44:47], v[108:111], v[148:151], v[44:47]
ds_read_b64_tr_b16 v[146:147], v164 offset:13824
v_mfma_f32_16x16x32_bf16 v[68:71], v[112:115], v[148:151], v[68:71]
ds_read_b128 v[128:131], v161 offset:4096
v_mfma_f32_16x16x32_bf16 v[92:95], v[116:119], v[148:151], v[92:95]
s_waitcnt lgkmcnt(11)
v_mfma_f32_16x16x32_bf16 v[24:27], v[104:107], v[152:155], v[24:27]
ds_read_b64_tr_b16 v[148:149], v165 offset:12288
v_mfma_f32_16x16x32_bf16 v[48:51], v[108:111], v[152:155], v[48:51]
ds_read_b64_tr_b16 v[150:151], v165 offset:13824
v_mfma_f32_16x16x32_bf16 v[72:75], v[112:115], v[152:155], v[72:75]
ds_read_b128 v[132:135], v161 offset:4608
v_mfma_f32_16x16x32_bf16 v[96:99], v[116:119], v[152:155], v[96:99]
s_waitcnt lgkmcnt(12)
v_mfma_f32_16x16x32_bf16 v[28:31], v[104:107], v[156:159], v[28:31]
ds_read_b64_tr_b16 v[152:153], v166 offset:12288
v_mfma_f32_16x16x32_bf16 v[52:55], v[108:111], v[156:159], v[52:55]
ds_read_b64_tr_b16 v[154:155], v166 offset:13824
v_mfma_f32_16x16x32_bf16 v[76:79], v[112:115], v[156:159], v[76:79]
v_mfma_f32_16x16x32_bf16 v[100:103], v[116:119], v[156:159], v[100:103]
s_waitcnt lgkmcnt(11)
v_mfma_f32_16x16x32_bf16 v[8:11], v[120:123], v[136:139], v[8:11]
ds_read_b64_tr_b16 v[156:157], v167 offset:12288
s_waitcnt lgkmcnt(9)
v_mfma_f32_16x16x32_bf16 v[32:35], v[124:127], v[136:139], v[32:35]
ds_read_b64_tr_b16 v[158:159], v167 offset:13824
s_waitcnt lgkmcnt(7)
v_mfma_f32_16x16x32_bf16 v[56:59], v[128:131], v[136:139], v[56:59]
s_waitcnt lgkmcnt(4)
v_mfma_f32_16x16x32_bf16 v[80:83], v[132:135], v[136:139], v[80:83]
v_mfma_f32_16x16x32_bf16 v[12:15], v[120:123], v[140:143], v[12:15]
v_mfma_f32_16x16x32_bf16 v[36:39], v[124:127], v[140:143], v[36:39]
v_mfma_f32_16x16x32_bf16 v[60:63], v[128:131], v[140:143], v[60:63]
v_mfma_f32_16x16x32_bf16 v[84:87], v[132:135], v[140:143], v[84:87]
s_waitcnt lgkmcnt(0)
s_barrier
v_mfma_f32_16x16x32_bf16 v[16:19], v[120:123], v[144:147], v[16:19]
ds_read_b64_tr_b16 v[136:137], v162 offset:24576
v_mfma_f32_16x16x32_bf16 v[40:43], v[124:127], v[144:147], v[40:43]
ds_read_b64_tr_b16 v[138:139], v162 offset:26112
v_mfma_f32_16x16x32_bf16 v[64:67], v[128:131], v[144:147], v[64:67]
ds_read_b128 v[104:107], v160 offset:16384
v_mfma_f32_16x16x32_bf16 v[88:91], v[132:135], v[144:147], v[88:91]
ds_read_b128 v[108:111], v160 offset:16896
v_mfma_f32_16x16x32_bf16 v[20:23], v[120:123], v[148:151], v[20:23]
ds_read_b64_tr_b16 v[140:141], v163 offset:24576
v_mfma_f32_16x16x32_bf16 v[44:47], v[124:127], v[148:151], v[44:47]
ds_read_b64_tr_b16 v[142:143], v163 offset:26112
v_mfma_f32_16x16x32_bf16 v[68:71], v[128:131], v[148:151], v[68:71]
ds_read_b128 v[112:115], v160 offset:20480
v_mfma_f32_16x16x32_bf16 v[92:95], v[132:135], v[148:151], v[92:95]
ds_read_b128 v[116:119], v160 offset:20992
v_mfma_f32_16x16x32_bf16 v[24:27], v[120:123], v[152:155], v[24:27]
ds_read_b64_tr_b16 v[144:145], v164 offset:24576
v_mfma_f32_16x16x32_bf16 v[48:51], v[124:127], v[152:155], v[48:51]
ds_read_b64_tr_b16 v[146:147], v164 offset:26112
v_mfma_f32_16x16x32_bf16 v[72:75], v[128:131], v[152:155], v[72:75]
ds_read_b64_tr_b16 v[148:149], v165 offset:24576
v_mfma_f32_16x16x32_bf16 v[96:99], v[132:135], v[152:155], v[96:99]
ds_read_b64_tr_b16 v[150:151], v165 offset:26112
v_mfma_f32_16x16x32_bf16 v[28:31], v[120:123], v[156:159], v[28:31]
ds_read_b64_tr_b16 v[152:153], v166 offset:24576
v_mfma_f32_16x16x32_bf16 v[52:55], v[124:127], v[156:159], v[52:55]
ds_read_b64_tr_b16 v[154:155], v166 offset:26112
v_mfma_f32_16x16x32_bf16 v[76:79], v[128:131], v[156:159], v[76:79]
v_mfma_f32_16x16x32_bf16 v[100:103], v[132:135], v[156:159], v[100:103]
s_waitcnt lgkmcnt(11)
v_mfma_f32_16x16x32_bf16 v[8:11], v[104:107], v[136:139], v[8:11]
ds_read_b64_tr_b16 v[156:157], v167 offset:24576
s_waitcnt lgkmcnt(11)
v_mfma_f32_16x16x32_bf16 v[32:35], v[108:111], v[136:139], v[32:35]
ds_read_b64_tr_b16 v[158:159], v167 offset:26112
s_waitcnt lgkmcnt(9)
v_mfma_f32_16x16x32_bf16 v[56:59], v[112:115], v[136:139], v[56:59]
s_waitcnt lgkmcnt(8)
v_mfma_f32_16x16x32_bf16 v[80:83], v[116:119], v[136:139], v[80:83]
v_mfma_f32_16x16x32_bf16 v[12:15], v[104:107], v[140:143], v[12:15]
ds_read_b64_tr_b16 v[136:137], v162 offset:36864
v_mfma_f32_16x16x32_bf16 v[36:39], v[108:111], v[140:143], v[36:39]
ds_read_b64_tr_b16 v[138:139], v162 offset:38400
v_mfma_f32_16x16x32_bf16 v[60:63], v[112:115], v[140:143], v[60:63]
ds_read_b128 v[120:123], v161 offset:16384
v_mfma_f32_16x16x32_bf16 v[84:87], v[116:119], v[140:143], v[84:87]
s_waitcnt lgkmcnt(9)
v_mfma_f32_16x16x32_bf16 v[16:19], v[104:107], v[144:147], v[16:19]
ds_read_b64_tr_b16 v[140:141], v163 offset:36864
v_mfma_f32_16x16x32_bf16 v[40:43], v[108:111], v[144:147], v[40:43]
ds_read_b64_tr_b16 v[142:143], v163 offset:38400
v_mfma_f32_16x16x32_bf16 v[64:67], v[112:115], v[144:147], v[64:67]
ds_read_b128 v[124:127], v161 offset:16896
v_mfma_f32_16x16x32_bf16 v[88:91], v[116:119], v[144:147], v[88:91]
s_waitcnt lgkmcnt(10)
v_mfma_f32_16x16x32_bf16 v[20:23], v[104:107], v[148:151], v[20:23]
ds_read_b64_tr_b16 v[144:145], v164 offset:36864
v_mfma_f32_16x16x32_bf16 v[44:47], v[108:111], v[148:151], v[44:47]
ds_read_b64_tr_b16 v[146:147], v164 offset:38400
v_mfma_f32_16x16x32_bf16 v[68:71], v[112:115], v[148:151], v[68:71]
ds_read_b128 v[128:131], v161 offset:20480
v_mfma_f32_16x16x32_bf16 v[92:95], v[116:119], v[148:151], v[92:95]
s_waitcnt lgkmcnt(11)
v_mfma_f32_16x16x32_bf16 v[24:27], v[104:107], v[152:155], v[24:27]
ds_read_b64_tr_b16 v[148:149], v165 offset:36864
v_mfma_f32_16x16x32_bf16 v[48:51], v[108:111], v[152:155], v[48:51]
ds_read_b64_tr_b16 v[150:151], v165 offset:38400
v_mfma_f32_16x16x32_bf16 v[72:75], v[112:115], v[152:155], v[72:75]
ds_read_b128 v[132:135], v161 offset:20992
v_mfma_f32_16x16x32_bf16 v[96:99], v[116:119], v[152:155], v[96:99]
s_waitcnt lgkmcnt(12)
v_mfma_f32_16x16x32_bf16 v[28:31], v[104:107], v[156:159], v[28:31]
ds_read_b64_tr_b16 v[152:153], v166 offset:36864
v_mfma_f32_16x16x32_bf16 v[52:55], v[108:111], v[156:159], v[52:55]
ds_read_b64_tr_b16 v[154:155], v166 offset:38400
v_mfma_f32_16x16x32_bf16 v[76:79], v[112:115], v[156:159], v[76:79]
v_mfma_f32_16x16x32_bf16 v[100:103], v[116:119], v[156:159], v[100:103]
s_waitcnt lgkmcnt(11)
v_mfma_f32_16x16x32_bf16 v[8:11], v[120:123], v[136:139], v[8:11]
ds_read_b64_tr_b16 v[156:157], v167 offset:36864
s_waitcnt lgkmcnt(9)
v_mfma_f32_16x16x32_bf16 v[32:35], v[124:127], v[136:139], v[32:35]
ds_read_b64_tr_b16 v[158:159], v167 offset:38400
s_waitcnt lgkmcnt(7)
v_mfma_f32_16x16x32_bf16 v[56:59], v[128:131], v[136:139], v[56:59]
s_waitcnt lgkmcnt(4)
v_mfma_f32_16x16x32_bf16 v[80:83], v[132:135], v[136:139], v[80:83]
v_mfma_f32_16x16x32_bf16 v[12:15], v[120:123], v[140:143], v[12:15]
v_mfma_f32_16x16x32_bf16 v[36:39], v[124:127], v[140:143], v[36:39]
v_mfma_f32_16x16x32_bf16 v[60:63], v[128:131], v[140:143], v[60:63]
v_mfma_f32_16x16x32_bf16 v[84:87], v[132:135], v[140:143], v[84:87]
s_waitcnt lgkmcnt(0)
s_barrier
v_mfma_f32_16x16x32_bf16 v[16:19], v[120:123], v[144:147], v[16:19]
ds_read_b64_tr_b16 v[136:137], v162 offset:49152
v_mfma_f32_16x16x32_bf16 v[40:43], v[124:127], v[144:147], v[40:43]
ds_read_b64_tr_b16 v[138:139], v162 offset:50688
v_mfma_f32_16x16x32_bf16 v[64:67], v[128:131], v[144:147], v[64:67]
ds_read_b128 v[104:107], v160 offset:32768
v_mfma_f32_16x16x32_bf16 v[88:91], v[132:135], v[144:147], v[88:91]
ds_read_b128 v[108:111], v160 offset:33280
v_mfma_f32_16x16x32_bf16 v[20:23], v[120:123], v[148:151], v[20:23]
ds_read_b64_tr_b16 v[140:141], v163 offset:49152
v_mfma_f32_16x16x32_bf16 v[44:47], v[124:127], v[148:151], v[44:47]
ds_read_b64_tr_b16 v[142:143], v163 offset:50688
v_mfma_f32_16x16x32_bf16 v[68:71], v[128:131], v[148:151], v[68:71]
ds_read_b128 v[112:115], v160 offset:36864
v_mfma_f32_16x16x32_bf16 v[92:95], v[132:135], v[148:151], v[92:95]
ds_read_b128 v[116:119], v160 offset:37376
v_mfma_f32_16x16x32_bf16 v[24:27], v[120:123], v[152:155], v[24:27]
ds_read_b64_tr_b16 v[144:145], v164 offset:49152
v_mfma_f32_16x16x32_bf16 v[48:51], v[124:127], v[152:155], v[48:51]
ds_read_b64_tr_b16 v[146:147], v164 offset:50688
v_mfma_f32_16x16x32_bf16 v[72:75], v[128:131], v[152:155], v[72:75]
ds_read_b64_tr_b16 v[148:149], v165 offset:49152
v_mfma_f32_16x16x32_bf16 v[96:99], v[132:135], v[152:155], v[96:99]
ds_read_b64_tr_b16 v[150:151], v165 offset:50688
v_mfma_f32_16x16x32_bf16 v[28:31], v[120:123], v[156:159], v[28:31]
ds_read_b64_tr_b16 v[152:153], v166 offset:49152
v_mfma_f32_16x16x32_bf16 v[52:55], v[124:127], v[156:159], v[52:55]
ds_read_b64_tr_b16 v[154:155], v166 offset:50688
v_mfma_f32_16x16x32_bf16 v[76:79], v[128:131], v[156:159], v[76:79]
v_mfma_f32_16x16x32_bf16 v[100:103], v[132:135], v[156:159], v[100:103]
s_waitcnt lgkmcnt(11)
v_mfma_f32_16x16x32_bf16 v[8:11], v[104:107], v[136:139], v[8:11]
ds_read_b64_tr_b16 v[156:157], v167 offset:49152
s_waitcnt lgkmcnt(11)
v_mfma_f32_16x16x32_bf16 v[32:35], v[108:111], v[136:139], v[32:35]
ds_read_b64_tr_b16 v[158:159], v167 offset:50688
s_waitcnt lgkmcnt(9)
v_mfma_f32_16x16x32_bf16 v[56:59], v[112:115], v[136:139], v[56:59]
s_waitcnt lgkmcnt(8)
v_mfma_f32_16x16x32_bf16 v[80:83], v[116:119], v[136:139], v[80:83]
v_mfma_f32_16x16x32_bf16 v[12:15], v[104:107], v[140:143], v[12:15]
ds_read_b64_tr_b16 v[136:137], v162 offset:61440
v_mfma_f32_16x16x32_bf16 v[36:39], v[108:111], v[140:143], v[36:39]
ds_read_b64_tr_b16 v[138:139], v162 offset:62976
v_mfma_f32_16x16x32_bf16 v[60:63], v[112:115], v[140:143], v[60:63]
ds_read_b128 v[120:123], v161 offset:32768
v_mfma_f32_16x16x32_bf16 v[84:87], v[116:119], v[140:143], v[84:87]
s_waitcnt lgkmcnt(9)
v_mfma_f32_16x16x32_bf16 v[16:19], v[104:107], v[144:147], v[16:19]
ds_read_b64_tr_b16 v[140:141], v163 offset:61440
v_mfma_f32_16x16x32_bf16 v[40:43], v[108:111], v[144:147], v[40:43]
ds_read_b64_tr_b16 v[142:143], v163 offset:62976
v_mfma_f32_16x16x32_bf16 v[64:67], v[112:115], v[144:147], v[64:67]
ds_read_b128 v[124:127], v161 offset:33280
v_mfma_f32_16x16x32_bf16 v[88:91], v[116:119], v[144:147], v[88:91]
s_waitcnt lgkmcnt(10)
v_mfma_f32_16x16x32_bf16 v[20:23], v[104:107], v[148:151], v[20:23]
ds_read_b64_tr_b16 v[144:145], v164 offset:61440
v_mfma_f32_16x16x32_bf16 v[44:47], v[108:111], v[148:151], v[44:47]
ds_read_b64_tr_b16 v[146:147], v164 offset:62976
v_mfma_f32_16x16x32_bf16 v[68:71], v[112:115], v[148:151], v[68:71]
ds_read_b128 v[128:131], v161 offset:36864
v_mfma_f32_16x16x32_bf16 v[92:95], v[116:119], v[148:151], v[92:95]
s_waitcnt lgkmcnt(11)
v_mfma_f32_16x16x32_bf16 v[24:27], v[104:107], v[152:155], v[24:27]
ds_read_b64_tr_b16 v[148:149], v165 offset:61440
v_mfma_f32_16x16x32_bf16 v[48:51], v[108:111], v[152:155], v[48:51]
ds_read_b64_tr_b16 v[150:151], v165 offset:62976
v_mfma_f32_16x16x32_bf16 v[72:75], v[112:115], v[152:155], v[72:75]
ds_read_b128 v[132:135], v161 offset:37376
v_mfma_f32_16x16x32_bf16 v[96:99], v[116:119], v[152:155], v[96:99]
s_waitcnt lgkmcnt(12)
v_mfma_f32_16x16x32_bf16 v[28:31], v[104:107], v[156:159], v[28:31]
ds_read_b64_tr_b16 v[152:153], v166 offset:61440
v_mfma_f32_16x16x32_bf16 v[52:55], v[108:111], v[156:159], v[52:55]
ds_read_b64_tr_b16 v[154:155], v166 offset:62976
v_mfma_f32_16x16x32_bf16 v[76:79], v[112:115], v[156:159], v[76:79]
v_mfma_f32_16x16x32_bf16 v[100:103], v[116:119], v[156:159], v[100:103]
s_waitcnt lgkmcnt(11)
v_mfma_f32_16x16x32_bf16 v[8:11], v[120:123], v[136:139], v[8:11]
ds_read_b64_tr_b16 v[156:157], v167 offset:61440
s_waitcnt lgkmcnt(9)
v_mfma_f32_16x16x32_bf16 v[32:35], v[124:127], v[136:139], v[32:35]
ds_read_b64_tr_b16 v[158:159], v167 offset:62976
s_waitcnt lgkmcnt(7)
v_mfma_f32_16x16x32_bf16 v[56:59], v[128:131], v[136:139], v[56:59]
s_waitcnt lgkmcnt(4)
v_mfma_f32_16x16x32_bf16 v[80:83], v[132:135], v[136:139], v[80:83]
v_mfma_f32_16x16x32_bf16 v[12:15], v[120:123], v[140:143], v[12:15]
v_mfma_f32_16x16x32_bf16 v[36:39], v[124:127], v[140:143], v[36:39]
v_mfma_f32_16x16x32_bf16 v[60:63], v[128:131], v[140:143], v[60:63]
v_mfma_f32_16x16x32_bf16 v[84:87], v[132:135], v[140:143], v[84:87]
v_mfma_f32_16x16x32_bf16 v[16:19], v[120:123], v[144:147], v[16:19]
v_mfma_f32_16x16x32_bf16 v[40:43], v[124:127], v[144:147], v[40:43]
v_mfma_f32_16x16x32_bf16 v[64:67], v[128:131], v[144:147], v[64:67]
v_mfma_f32_16x16x32_bf16 v[88:91], v[132:135], v[144:147], v[88:91]
v_mfma_f32_16x16x32_bf16 v[20:23], v[120:123], v[148:151], v[20:23]
v_mfma_f32_16x16x32_bf16 v[44:47], v[124:127], v[148:151], v[44:47]
v_mfma_f32_16x16x32_bf16 v[68:71], v[128:131], v[148:151], v[68:71]
v_mfma_f32_16x16x32_bf16 v[92:95], v[132:135], v[148:151], v[92:95]
s_waitcnt lgkmcnt(2)
v_mfma_f32_16x16x32_bf16 v[24:27], v[120:123], v[152:155], v[24:27]
v_mfma_f32_16x16x32_bf16 v[48:51], v[124:127], v[152:155], v[48:51]
v_mfma_f32_16x16x32_bf16 v[72:75], v[128:131], v[152:155], v[72:75]
v_mfma_f32_16x16x32_bf16 v[96:99], v[132:135], v[152:155], v[96:99]
s_waitcnt lgkmcnt(0)
v_mfma_f32_16x16x32_bf16 v[28:31], v[120:123], v[156:159], v[28:31]
v_mfma_f32_16x16x32_bf16 v[52:55], v[124:127], v[156:159], v[52:55]
v_mfma_f32_16x16x32_bf16 v[76:79], v[128:131], v[156:159], v[76:79]
v_mfma_f32_16x16x32_bf16 v[100:103], v[132:135], v[156:159], v[100:103]
v_mov_b32 v111, 0
v_mov_b32 v110, 16
s_cmp_lg_u32 s20, 0
s_cbranch_scc1 GM_nofl
s_mov_b64 exec, 1
buffer_load_dword v110, v111, s[44:47], 0 offen offset:208 sc1
s_mov_b64 exec, -1
GM_nofl:
v_mov_b32 v108, 0x3fb8aa3b
v_mov_b32 v109, 0x3fb8aa3b
s_mov_b32 s56, 0x358637bd
v_lshlrev_b32 v112, 6, v6
v_lshl_add_u32 v112, v7, 4, v112
v_add_u32 v1, 36864, v112
s_lshl_b32 s57, s28, 1
s_add_u32 s57, s57, s48
s_mul_i32 s57, s57, 73728
s_cmp_eq_u32 s27, 8
s_cbranch_scc1 GM_epi_q
v_cmp_eq_u32 s[64:65], 1, v5
v_mov_b32 v3, 0x3f803f80
v_pk_mul_f32 v[104:105], v[8:9], v[108:109]
v_pk_mul_f32 v[106:107], v[10:11], v[108:109]
v_exp_f32_e64 v104, v104 clamp
v_exp_f32_e64 v105, v105 clamp
v_exp_f32_e64 v106, v106 clamp
v_exp_f32_e64 v107, v107 clamp
v_max_f32 v8, s56, v8
v_max_f32 v9, s56, v9
v_max_f32 v10, s56, v10
v_max_f32 v11, s56, v11
v_pk_add_f32 v[8:9], v[8:9], v[104:105]
v_pk_add_f32 v[10:11], v[10:11], v[106:107]
v_cvt_pk_bf16_f32 v114, v8, v9
v_cvt_pk_bf16_f32 v115, v10, v11
v_pk_mul_f32 v[104:105], v[12:13], v[108:109]
v_pk_mul_f32 v[106:107], v[14:15], v[108:109]
v_exp_f32_e64 v104, v104 clamp
v_exp_f32_e64 v105, v105 clamp
v_exp_f32_e64 v106, v106 clamp
v_exp_f32_e64 v107, v107 clamp
v_max_f32 v12, s56, v12
v_max_f32 v13, s56, v13
v_max_f32 v14, s56, v14
v_max_f32 v15, s56, v15
v_pk_add_f32 v[12:13], v[12:13], v[104:105]
v_pk_add_f32 v[14:15], v[14:15], v[106:107]
v_cvt_pk_bf16_f32 v122, v12, v13
v_cvt_pk_bf16_f32 v123, v14, v15
v_pk_mul_f32 v[104:105], v[24:25], v[108:109]
v_pk_mul_f32 v[106:107], v[26:27], v[108:109]
v_exp_f32_e64 v104, v104 clamp
v_exp_f32_e64 v105, v105 clamp
v_exp_f32_e64 v106, v106 clamp
v_exp_f32_e64 v107, v107 clamp
s_mov_b64 exec, s[66:67]
v_max_f32 v24, s56, v24
v_max_f32 v25, s56, v25
v_max_f32 v26, s56, v26
v_max_f32 v27, s56, v27
v_pk_add_f32 v[24:25], v[24:25], v[104:105]
v_pk_add_f32 v[26:27], v[26:27], v[106:107]
s_mov_b64 exec, -1
v_cvt_pk_bf16_f32 v146, v24, v25
v_cvt_pk_bf16_f32 v147, v26, v27
v_cvt_pk_bf16_f32 v130, v16, v17
v_cvt_pk_bf16_f32 v131, v18, v19
v_cvt_pk_bf16_f32 v138, v20, v21
v_cvt_pk_bf16_f32 v139, v22, v23
v_pk_mul_f32 v[104:105], v[32:33], v[108:109]
v_pk_mul_f32 v[106:107], v[34:35], v[108:109]
v_exp_f32_e64 v104, v104 clamp
v_exp_f32_e64 v105, v105 clamp
v_exp_f32_e64 v106, v106 clamp
v_exp_f32_e64 v107, v107 clamp
v_max_f32 v32, s56, v32
v_max_f32 v33, s56, v33
v_max_f32 v34, s56, v34
v_max_f32 v35, s56, v35
v_pk_add_f32 v[32:33], v[32:33], v[104:105]
v_pk_add_f32 v[34:35], v[34:35], v[106:107]
v_cvt_pk_bf16_f32 v116, v32, v33
v_cvt_pk_bf16_f32 v117, v34, v35
v_pk_mul_f32 v[104:105], v[36:37], v[108:109]
v_pk_mul_f32 v[106:107], v[38:39], v[108:109]
v_exp_f32_e64 v104, v104 clamp
v_exp_f32_e64 v105, v105 clamp
v_exp_f32_e64 v106, v106 clamp
v_exp_f32_e64 v107, v107 clamp
v_max_f32 v36, s56, v36
v_max_f32 v37, s56, v37
v_max_f32 v38, s56, v38
v_max_f32 v39, s56, v39
v_pk_add_f32 v[36:37], v[36:37], v[104:105]
v_pk_add_f32 v[38:39], v[38:39], v[106:107]
v_cvt_pk_bf16_f32 v124, v36, v37
v_cvt_pk_bf16_f32 v125, v38, v39
v_pk_mul_f32 v[104:105], v[48:49], v[108:109]
v_pk_mul_f32 v[106:107], v[50:51], v[108:109]
v_exp_f32_e64 v104, v104 clamp
v_exp_f32_e64 v105, v105 clamp
v_exp_f32_e64 v106, v106 clamp
v_exp_f32_e64 v107, v107 clamp
s_mov_b64 exec, s[66:67]
v_max_f32 v48, s56, v48
v_max_f32 v49, s56, v49
v_max_f32 v50, s56, v50
v_max_f32 v51, s56, v51
v_pk_add_f32 v[48:49], v[48:49], v[104:105]
v_pk_add_f32 v[50:51], v[50:51], v[106:107]
s_mov_b64 exec, -1
v_cvt_pk_bf16_f32 v148, v48, v49
v_cvt_pk_bf16_f32 v149, v50, v51
v_cvt_pk_bf16_f32 v132, v40, v41
v_cvt_pk_bf16_f32 v133, v42, v43
v_cvt_pk_bf16_f32 v140, v44, v45
v_cvt_pk_bf16_f32 v141, v46, v47
v_cndmask_b32 v154, v3, v146, s[64:65]
v_cndmask_b32 v155, v3, v147, s[64:65]
v_cndmask_b32 v156, v3, v148, s[64:65]
v_cndmask_b32 v157, v3, v149, s[64:65]
v_mfma_f32_16x16x32_bf16 v[8:11], v[130:133], v[114:117], 0
v_mfma_f32_16x16x32_bf16 v[12:15], v[138:141], v[122:125], 0
v_mfma_f32_16x16x32_bf16 v[16:19], v[154:157], v[114:117], 0
v_mfma_f32_16x16x32_bf16 v[20:23], v[154:157], v[122:125], 0
v_mfma_f32_16x16x32_bf16 v[24:27], v[130:133], v[146:149], 0
v_mfma_f32_16x16x32_bf16 v[32:35], v[138:141], v[146:149], 0
v_mfma_f32_16x16x32_bf16 v[36:39], v[154:157], v[146:149], 0
v_pk_mul_f32 v[104:105], v[56:57], v[108:109]
v_pk_mul_f32 v[106:107], v[58:59], v[108:109]
v_exp_f32_e64 v104, v104 clamp
v_exp_f32_e64 v105, v105 clamp
v_exp_f32_e64 v106, v106 clamp
v_exp_f32_e64 v107, v107 clamp
v_max_f32 v56, s56, v56
v_max_f32 v57, s56, v57
v_max_f32 v58, s56, v58
v_max_f32 v59, s56, v59
v_pk_add_f32 v[56:57], v[56:57], v[104:105]
v_pk_add_f32 v[58:59], v[58:59], v[106:107]
v_cvt_pk_bf16_f32 v118, v56, v57
v_cvt_pk_bf16_f32 v119, v58, v59
v_pk_mul_f32 v[104:105], v[60:61], v[108:109]
v_pk_mul_f32 v[106:107], v[62:63], v[108:109]
v_exp_f32_e64 v104, v104 clamp
v_exp_f32_e64 v105, v105 clamp
v_exp_f32_e64 v106, v106 clamp
v_exp_f32_e64 v107, v107 clamp
v_max_f32 v60, s56, v60
v_max_f32 v61, s56, v61
v_max_f32 v62, s56, v62
v_max_f32 v63, s56, v63
v_pk_add_f32 v[60:61], v[60:61], v[104:105]
v_pk_add_f32 v[62:63], v[62:63], v[106:107]
v_cvt_pk_bf16_f32 v126, v60, v61
v_cvt_pk_bf16_f32 v127, v62, v63
v_pk_mul_f32 v[104:105], v[72:73], v[108:109]
v_pk_mul_f32 v[106:107], v[74:75], v[108:109]
v_exp_f32_e64 v104, v104 clamp
v_exp_f32_e64 v105, v105 clamp
v_exp_f32_e64 v106, v106 clamp
v_exp_f32_e64 v107, v107 clamp
s_mov_b64 exec, s[66:67]
v_max_f32 v72, s56, v72
v_max_f32 v73, s56, v73
v_max_f32 v74, s56, v74
v_max_f32 v75, s56, v75
v_pk_add_f32 v[72:73], v[72:73], v[104:105]
v_pk_add_f32 v[74:75], v[74:75], v[106:107]
s_mov_b64 exec, -1
v_cvt_pk_bf16_f32 v150, v72, v73
v_cvt_pk_bf16_f32 v151, v74, v75
v_cvt_pk_bf16_f32 v134, v64, v65
v_cvt_pk_bf16_f32 v135, v66, v67
v_cvt_pk_bf16_f32 v142, v68, v69
v_cvt_pk_bf16_f32 v143, v70, v71
v_pk_mul_f32 v[104:105], v[80:81], v[108:109]
v_pk_mul_f32 v[106:107], v[82:83], v[108:109]
v_exp_f32_e64 v104, v104 clamp
v_exp_f32_e64 v105, v105 clamp
v_exp_f32_e64 v106, v106 clamp
v_exp_f32_e64 v107, v107 clamp
v_max_f32 v80, s56, v80
v_max_f32 v81, s56, v81
v_max_f32 v82, s56, v82
v_max_f32 v83, s56, v83
v_pk_add_f32 v[80:81], v[80:81], v[104:105]
v_pk_add_f32 v[82:83], v[82:83], v[106:107]
v_cvt_pk_bf16_f32 v120, v80, v81
v_cvt_pk_bf16_f32 v121, v82, v83
v_pk_mul_f32 v[104:105], v[84:85], v[108:109]
v_pk_mul_f32 v[106:107], v[86:87], v[108:109]
v_exp_f32_e64 v104, v104 clamp
v_exp_f32_e64 v105, v105 clamp
v_exp_f32_e64 v106, v106 clamp
v_exp_f32_e64 v107, v107 clamp
v_max_f32 v84, s56, v84
v_max_f32 v85, s56, v85
v_max_f32 v86, s56, v86
v_max_f32 v87, s56, v87
v_pk_add_f32 v[84:85], v[84:85], v[104:105]
v_pk_add_f32 v[86:87], v[86:87], v[106:107]
v_cvt_pk_bf16_f32 v128, v84, v85
v_cvt_pk_bf16_f32 v129, v86, v87
v_pk_mul_f32 v[104:105], v[96:97], v[108:109]
v_pk_mul_f32 v[106:107], v[98:99], v[108:109]
v_exp_f32_e64 v104, v104 clamp
v_exp_f32_e64 v105, v105 clamp
v_exp_f32_e64 v106, v106 clamp
v_exp_f32_e64 v107, v107 clamp
s_mov_b64 exec, s[66:67]
v_max_f32 v96, s56, v96
v_max_f32 v97, s56, v97
v_max_f32 v98, s56, v98
v_max_f32 v99, s56, v99
v_pk_add_f32 v[96:97], v[96:97], v[104:105]
v_pk_add_f32 v[98:99], v[98:99], v[106:107]
s_mov_b64 exec, -1
v_cvt_pk_bf16_f32 v152, v96, v97
v_cvt_pk_bf16_f32 v153, v98, v99
v_cvt_pk_bf16_f32 v136, v88, v89
v_cvt_pk_bf16_f32 v137, v90, v91
v_cvt_pk_bf16_f32 v144, v92, v93
v_cvt_pk_bf16_f32 v145, v94, v95
v_cndmask_b32 v158, v3, v150, s[64:65]
v_cndmask_b32 v159, v3, v151, s[64:65]
v_cndmask_b32 v160, v3, v152, s[64:65]
v_cndmask_b32 v161, v3, v153, s[64:65]
v_mfma_f32_16x16x32_bf16 v[8:11], v[134:137], v[118:121], v[8:11]
v_mfma_f32_16x16x32_bf16 v[12:15], v[142:145], v[126:129], v[12:15]
v_mfma_f32_16x16x32_bf16 v[16:19], v[158:161], v[118:121], v[16:19]
v_mfma_f32_16x16x32_bf16 v[20:23], v[158:161], v[126:129], v[20:23]
v_mfma_f32_16x16x32_bf16 v[24:27], v[134:137], v[150:153], v[24:27]
v_mfma_f32_16x16x32_bf16 v[32:35], v[142:145], v[150:153], v[32:35]
v_mfma_f32_16x16x32_bf16 v[36:39], v[158:161], v[150:153], v[36:39]
s_mul_i32 s63, s48, 7424
s_mul_i32 s60, s49, 3648
s_add_u32 s60, s60, s63
s_add_u32 s60, s60, 122880
v_mul_u32_u24 v154, 384, v7
v_lshl_add_u32 v154, v6, 2, v154
v_add_u32 v154, s60, v154
v_lshlrev_b32 v155, 2, v6
v_add_u32 v155, s60, v155
s_mul_i32 s58, s27, 48
s_mul_i32 s59, s49, 24
s_add_u32 s58, s58, s59
s_lshl_b32 s58, s58, 6
s_add_u32 s58, s58, s57
s_add_u32 s59, s58, 512
s_sub_u32 s58, s58, 512
ds_write_b32 v154, v8 offset:0
ds_write_b32 v154, v9 offset:96
ds_write_b32 v154, v10 offset:192
ds_write_b32 v154, v11 offset:288
ds_write_b32 v154, v12 offset:2024
ds_write_b32 v154, v13 offset:2120
ds_write_b32 v154, v14 offset:2216
ds_write_b32 v154, v15 offset:2312
s_mov_b64 exec, s[68:69]
ds_write_b32 v155, v16 offset:1536
ds_write_b32 v155, v17 offset:1632
ds_write_b32 v155, v22 offset:1832
ds_write_b32 v155, v23 offset:1928
s_mov_b64 exec, s[70:71]
ds_write_b32 v155, v16 offset:1728
ds_write_b32 v155, v20 offset:3560
s_mov_b64 exec, s[72:73]
ds_write_b32 v154, v24 offset:64
ds_write_b32 v154, v25 offset:160
ds_write_b32 v154, v26 offset:256
ds_write_b32 v154, v27 offset:352
s_mov_b64 exec, s[74:75]
ds_write_b32 v154, v32 offset:2008
ds_write_b32 v154, v33 offset:2104
ds_write_b32 v154, v34 offset:2200
ds_write_b32 v154, v35 offset:2296
s_mov_b64 exec, s[76:77]
ds_write_b32 v155, v36 offset:1600
ds_write_b32 v155, v37 offset:1696
s_mov_b64 exec, s[78:79]
ds_write_b32 v155, v38 offset:1816
ds_write_b32 v155, v39 offset:1912
s_mov_b64 exec, s[80:81]
ds_write_b32 v155, v36 offset:1792
s_mov_b64 exec, s[82:83]
ds_write_b32 v155, v36 offset:3544
s_mov_b64 exec, -1
s_waitcnt vmcnt(0)
v_readfirstlane_b32 s32, v110
s_nop 0
s_cmp_ge_u32 s32, 16
s_nop 2
s_cbranch_scc1 GM_flagok
s_mov_b64 exec, 1
GM_poll:
s_sleep 8
buffer_load_dword v110, v111, s[44:47], 0 offen offset:208 sc1
s_waitcnt vmcnt(0)
v_readfirstlane_b32 s32, v110
s_nop 1
s_cmp_lt_u32 s32, 16
s_cbranch_scc1 GM_poll
s_mov_b64 exec, -1
GM_flagok:
v_add_u32 v2, s58, v112
s_mov_b32 s62, 36864
s_mov_b64 exec, s[84:85]
buffer_store_dwordx4 v[146:149], v2, s[40:43], 0 offen sc1
buffer_store_dwordx4 v[150:153], v2, s[40:43], s62 offen sc1
s_mov_b64 exec, -1
s_waitcnt lgkmcnt(0)
s_barrier
v_lshlrev_b32 v2, 2, v0
v_add_u32 v3, 122880, v2
ds_read_b32 v56, v3 offset:0
ds_read_b32 v57, v3 offset:1024
ds_read_b32 v58, v3 offset:2048
ds_read_b32 v59, v3 offset:3072
ds_read_b32 v60, v3 offset:4096
ds_read_b32 v61, v3 offset:5120
ds_read_b32 v62, v3 offset:6144
ds_read_b32 v63, v3 offset:7168
ds_read_b32 v80, v3 offset:7424
ds_read_b32 v81, v3 offset:8448
ds_read_b32 v82, v3 offset:9472
ds_read_b32 v83, v3 offset:10496
ds_read_b32 v84, v3 offset:11520
ds_read_b32 v85, v3 offset:12544
ds_read_b32 v86, v3 offset:13568
v_min_u32 v4, 123004, v3
ds_read_b32 v87, v4 offset:14592
s_mul_i32 s33, s27, 7296
s_add_u32 s33, s33, 5439488
v_mov_b32 v4, 0x7f000000
v_cmp_gt_u32 vcc, 32, v0
s_nop 1
v_cndmask_b32 v3, v4, v2, vcc
s_waitcnt lgkmcnt(7)
v_add_f32 v56, v56, v80
s_waitcnt lgkmcnt(6)
v_add_f32 v57, v57, v81
s_waitcnt lgkmcnt(5)
v_add_f32 v58, v58, v82
s_waitcnt lgkmcnt(4)
v_add_f32 v59, v59, v83
s_waitcnt lgkmcnt(3)
v_add_f32 v60, v60, v84
s_waitcnt lgkmcnt(2)
v_add_f32 v61, v61, v85
s_waitcnt lgkmcnt(1)
v_add_f32 v62, v62, v86
s_waitcnt lgkmcnt(0)
v_add_f32 v63, v63, v87
buffer_atomic_add_f32 v56, v2, s[40:43], s33 offen offset:0
buffer_atomic_add_f32 v57, v2, s[40:43], s33 offen offset:1024
buffer_atomic_add_f32 v58, v2, s[40:43], s33 offen offset:2048
buffer_atomic_add_f32 v59, v2, s[40:43], s33 offen offset:3072
s_add_u32 s33, s33, 4096
buffer_atomic_add_f32 v60, v2, s[40:43], s33 offen
buffer_atomic_add_f32 v61, v2, s[40:43], s33 offen offset:1024
buffer_atomic_add_f32 v62, v2, s[40:43], s33 offen offset:2048
buffer_atomic_add_f32 v63, v3, s[40:43], s33 offen offset:3072
v_pk_mul_f32 v[104:105], v[28:29], v[108:109]
v_pk_mul_f32 v[106:107], v[30:31], v[108:109]
v_exp_f32_e64 v104, v104 clamp
v_exp_f32_e64 v105, v105 clamp
v_exp_f32_e64 v106, v106 clamp
v_exp_f32_e64 v107, v107 clamp
v_max_f32 v28, s56, v28
v_max_f32 v29, s56, v29
v_max_f32 v30, s56, v30
v_max_f32 v31, s56, v31
v_pk_add_f32 v[28:29], v[28:29], v[104:105]
v_pk_add_f32 v[30:31], v[30:31], v[106:107]
v_cvt_pk_bf16_f32 v114, v28, v29
v_cvt_pk_bf16_f32 v115, v30, v31
v_pk_mul_f32 v[104:105], v[52:53], v[108:109]
v_pk_mul_f32 v[106:107], v[54:55], v[108:109]
v_exp_f32_e64 v104, v104 clamp
v_exp_f32_e64 v105, v105 clamp
v_exp_f32_e64 v106, v106 clamp
v_exp_f32_e64 v107, v107 clamp
v_max_f32 v52, s56, v52
v_max_f32 v53, s56, v53
v_max_f32 v54, s56, v54
v_max_f32 v55, s56, v55
v_pk_add_f32 v[52:53], v[52:53], v[104:105]
v_pk_add_f32 v[54:55], v[54:55], v[106:107]
v_cvt_pk_bf16_f32 v116, v52, v53
v_cvt_pk_bf16_f32 v117, v54, v55
buffer_store_dwordx4 v[114:117], v112, s[40:43], s59 offen sc1
v_pk_mul_f32 v[104:105], v[76:77], v[108:109]
v_pk_mul_f32 v[106:107], v[78:79], v[108:109]
v_exp_f32_e64 v104, v104 clamp
v_exp_f32_e64 v105, v105 clamp
v_exp_f32_e64 v106, v106 clamp
v_exp_f32_e64 v107, v107 clamp
v_max_f32 v76, s56, v76
v_max_f32 v77, s56, v77
v_max_f32 v78, s56, v78
v_max_f32 v79, s56, v79
v_pk_add_f32 v[76:77], v[76:77], v[104:105]
v_pk_add_f32 v[78:79], v[78:79], v[106:107]
v_cvt_pk_bf16_f32 v118, v76, v77
v_cvt_pk_bf16_f32 v119, v78, v79
v_pk_mul_f32 v[104:105], v[100:101], v[108:109]
v_pk_mul_f32 v[106:107], v[102:103], v[108:109]
v_exp_f32_e64 v104, v104 clamp
v_exp_f32_e64 v105, v105 clamp
v_exp_f32_e64 v106, v106 clamp
v_exp_f32_e64 v107, v107 clamp
v_max_f32 v100, s56, v100
v_max_f32 v101, s56, v101
v_max_f32 v102, s56, v102
v_max_f32 v103, s56, v103
v_pk_add_f32 v[100:101], v[100:101], v[104:105]
v_pk_add_f32 v[102:103], v[102:103], v[106:107]
v_cvt_pk_bf16_f32 v120, v100, v101
v_cvt_pk_bf16_f32 v121, v102, v103
buffer_store_dwordx4 v[118:121], v1, s[40:43], s59 offen sc1
s_endpgm
GM_epi_q:
s_mul_i32 s58, s49, 96
s_add_u32 s58, s58, 384
s_lshl_b32 s58, s58, 6
s_add_u32 s58, s58, s57
v_pk_mul_f32 v[104:105], v[8:9], v[108:109]
v_pk_mul_f32 v[106:107], v[10:11], v[108:109]
v_exp_f32_e64 v104, v104 clamp
v_exp_f32_e64 v105, v105 clamp
v_exp_f32_e64 v106, v106 clamp
v_exp_f32_e64 v107, v107 clamp
v_max_f32 v8, s56, v8
v_max_f32 v9, s56, v9
v_max_f32 v10, s56, v10
v_max_f32 v11, s56, v11
v_pk_add_f32 v[8:9], v[8:9], v[104:105]
v_pk_add_f32 v[10:11], v[10:11], v[106:107]
v_cvt_pk_bf16_f32 v114, v8, v9
v_cvt_pk_bf16_f32 v115, v10, v11
v_pk_mul_f32 v[104:105], v[32:33], v[108:109]
v_pk_mul_f32 v[106:107], v[34:35], v[108:109]
v_exp_f32_e64 v104, v104 clamp
v_exp_f32_e64 v105, v105 clamp
v_exp_f32_e64 v106, v106 clamp
v_exp_f32_e64 v107, v107 clamp
v_max_f32 v32, s56, v32
v_max_f32 v33, s56, v33
v_max_f32 v34, s56, v34
v_max_f32 v35, s56, v35
v_pk_add_f32 v[32:33], v[32:33], v[104:105]
v_pk_add_f32 v[34:35], v[34:35], v[106:107]
v_cvt_pk_bf16_f32 v116, v32, v33
v_cvt_pk_bf16_f32 v117, v34, v35
buffer_store_dwordx4 v[114:117], v112, s[40:43], s58 offen sc1
v_pk_mul_f32 v[104:105], v[56:57], v[108:109]
v_pk_mul_f32 v[106:107], v[58:59], v[108:109]
v_exp_f32_e64 v104, v104 clamp
v_exp_f32_e64 v105, v105 clamp
v_exp_f32_e64 v106, v106 clamp
v_exp_f32_e64 v107, v107 clamp
v_max_f32 v56, s56, v56
v_max_f32 v57, s56, v57
v_max_f32 v58, s56, v58
v_max_f32 v59, s56, v59
v_pk_add_f32 v[56:57], v[56:57], v[104:105]
v_pk_add_f32 v[58:59], v[58:59], v[106:107]
v_cvt_pk_bf16_f32 v118, v56, v57
v_cvt_pk_bf16_f32 v119, v58, v59
v_pk_mul_f32 v[104:105], v[80:81], v[108:109]
v_pk_mul_f32 v[106:107], v[82:83], v[108:109]
v_exp_f32_e64 v104, v104 clamp
v_exp_f32_e64 v105, v105 clamp
v_exp_f32_e64 v106, v106 clamp
v_exp_f32_e64 v107, v107 clamp
v_max_f32 v80, s56, v80
v_max_f32 v81, s56, v81
v_max_f32 v82, s56, v82
v_max_f32 v83, s56, v83
v_pk_add_f32 v[80:81], v[80:81], v[104:105]
v_pk_add_f32 v[82:83], v[82:83], v[106:107]
v_cvt_pk_bf16_f32 v120, v80, v81
v_cvt_pk_bf16_f32 v121, v82, v83
buffer_store_dwordx4 v[118:121], v1, s[40:43], s58 offen sc1
s_add_u32 s58, s58, 1024
v_pk_mul_f32 v[104:105], v[12:13], v[108:109]
v_pk_mul_f32 v[106:107], v[14:15], v[108:109]
v_exp_f32_e64 v104, v104 clamp
v_exp_f32_e64 v105, v105 clamp
v_exp_f32_e64 v106, v106 clamp
v_exp_f32_e64 v107, v107 clamp
v_max_f32 v12, s56, v12
v_max_f32 v13, s56, v13
v_max_f32 v14, s56, v14
v_max_f32 v15, s56, v15
v_pk_add_f32 v[12:13], v[12:13], v[104:105]
v_pk_add_f32 v[14:15], v[14:15], v[106:107]
v_cvt_pk_bf16_f32 v122, v12, v13
v_cvt_pk_bf16_f32 v123, v14, v15
v_pk_mul_f32 v[104:105], v[36:37], v[108:109]
v_pk_mul_f32 v[106:107], v[38:39], v[108:109]
v_exp_f32_e64 v104, v104 clamp
v_exp_f32_e64 v105, v105 clamp
v_exp_f32_e64 v106, v106 clamp
v_exp_f32_e64 v107, v107 clamp
v_max_f32 v36, s56, v36
v_max_f32 v37, s56, v37
v_max_f32 v38, s56, v38
v_max_f32 v39, s56, v39
v_pk_add_f32 v[36:37], v[36:37], v[104:105]
v_pk_add_f32 v[38:39], v[38:39], v[106:107]
v_cvt_pk_bf16_f32 v124, v36, v37
v_cvt_pk_bf16_f32 v125, v38, v39
buffer_store_dwordx4 v[122:125], v112, s[40:43], s58 offen sc1
v_pk_mul_f32 v[104:105], v[60:61], v[108:109]
v_pk_mul_f32 v[106:107], v[62:63], v[108:109]
v_exp_f32_e64 v104, v104 clamp
v_exp_f32_e64 v105, v105 clamp
v_exp_f32_e64 v106, v106 clamp
v_exp_f32_e64 v107, v107 clamp
v_max_f32 v60, s56, v60
v_max_f32 v61, s56, v61
v_max_f32 v62, s56, v62
v_max_f32 v63, s56, v63
v_pk_add_f32 v[60:61], v[60:61], v[104:105]
v_pk_add_f32 v[62:63], v[62:63], v[106:107]
v_cvt_pk_bf16_f32 v126, v60, v61
v_cvt_pk_bf16_f32 v127, v62, v63
v_pk_mul_f32 v[104:105], v[84:85], v[108:109]
v_pk_mul_f32 v[106:107], v[86:87], v[108:109]
v_exp_f32_e64 v104, v104 clamp
v_exp_f32_e64 v105, v105 clamp
v_exp_f32_e64 v106, v106 clamp
v_exp_f32_e64 v107, v107 clamp
v_max_f32 v84, s56, v84
v_max_f32 v85, s56, v85
v_max_f32 v86, s56, v86
v_max_f32 v87, s56, v87
v_pk_add_f32 v[84:85], v[84:85], v[104:105]
v_pk_add_f32 v[86:87], v[86:87], v[106:107]
v_cvt_pk_bf16_f32 v128, v84, v85
v_cvt_pk_bf16_f32 v129, v86, v87
buffer_store_dwordx4 v[126:129], v1, s[40:43], s58 offen sc1
s_add_u32 s58, s58, 1024
v_pk_mul_f32 v[104:105], v[16:17], v[108:109]
v_pk_mul_f32 v[106:107], v[18:19], v[108:109]
v_exp_f32_e64 v104, v104 clamp
v_exp_f32_e64 v105, v105 clamp
v_exp_f32_e64 v106, v106 clamp
v_exp_f32_e64 v107, v107 clamp
v_max_f32 v16, s56, v16
v_max_f32 v17, s56, v17
v_max_f32 v18, s56, v18
v_max_f32 v19, s56, v19
v_pk_add_f32 v[16:17], v[16:17], v[104:105]
v_pk_add_f32 v[18:19], v[18:19], v[106:107]
v_cvt_pk_bf16_f32 v130, v16, v17
v_cvt_pk_bf16_f32 v131, v18, v19
v_pk_mul_f32 v[104:105], v[40:41], v[108:109]
v_pk_mul_f32 v[106:107], v[42:43], v[108:109]
v_exp_f32_e64 v104, v104 clamp
v_exp_f32_e64 v105, v105 clamp
v_exp_f32_e64 v106, v106 clamp
v_exp_f32_e64 v107, v107 clamp
v_max_f32 v40, s56, v40
v_max_f32 v41, s56, v41
v_max_f32 v42, s56, v42
v_max_f32 v43, s56, v43
v_pk_add_f32 v[40:41], v[40:41], v[104:105]
v_pk_add_f32 v[42:43], v[42:43], v[106:107]
v_cvt_pk_bf16_f32 v132, v40, v41
v_cvt_pk_bf16_f32 v133, v42, v43
buffer_store_dwordx4 v[130:133], v112, s[40:43], s58 offen sc1
v_pk_mul_f32 v[104:105], v[64:65], v[108:109]
v_pk_mul_f32 v[106:107], v[66:67], v[108:109]
v_exp_f32_e64 v104, v104 clamp
v_exp_f32_e64 v105, v105 clamp
v_exp_f32_e64 v106, v106 clamp
v_exp_f32_e64 v107, v107 clamp
v_max_f32 v64, s56, v64
v_max_f32 v65, s56, v65
v_max_f32 v66, s56, v66
v_max_f32 v67, s56, v67
v_pk_add_f32 v[64:65], v[64:65], v[104:105]
v_pk_add_f32 v[66:67], v[66:67], v[106:107]
v_cvt_pk_bf16_f32 v134, v64, v65
v_cvt_pk_bf16_f32 v135, v66, v67
v_pk_mul_f32 v[104:105], v[88:89], v[108:109]
v_pk_mul_f32 v[106:107], v[90:91], v[108:109]
v_exp_f32_e64 v104, v104 clamp
v_exp_f32_e64 v105, v105 clamp
v_exp_f32_e64 v106, v106 clamp
v_exp_f32_e64 v107, v107 clamp
v_max_f32 v88, s56, v88
v_max_f32 v89, s56, v89
v_max_f32 v90, s56, v90
v_max_f32 v91, s56, v91
v_pk_add_f32 v[88:89], v[88:89], v[104:105]
v_pk_add_f32 v[90:91], v[90:91], v[106:107]
v_cvt_pk_bf16_f32 v136, v88, v89
v_cvt_pk_bf16_f32 v137, v90, v91
buffer_store_dwordx4 v[134:137], v1, s[40:43], s58 offen sc1
s_add_u32 s58, s58, 1024
v_pk_mul_f32 v[104:105], v[20:21], v[108:109]
v_pk_mul_f32 v[106:107], v[22:23], v[108:109]
v_exp_f32_e64 v104, v104 clamp
v_exp_f32_e64 v105, v105 clamp
v_exp_f32_e64 v106, v106 clamp
v_exp_f32_e64 v107, v107 clamp
v_max_f32 v20, s56, v20
v_max_f32 v21, s56, v21
v_max_f32 v22, s56, v22
v_max_f32 v23, s56, v23
v_pk_add_f32 v[20:21], v[20:21], v[104:105]
v_pk_add_f32 v[22:23], v[22:23], v[106:107]
v_cvt_pk_bf16_f32 v138, v20, v21
v_cvt_pk_bf16_f32 v139, v22, v23
v_pk_mul_f32 v[104:105], v[44:45], v[108:109]
v_pk_mul_f32 v[106:107], v[46:47], v[108:109]
v_exp_f32_e64 v104, v104 clamp
v_exp_f32_e64 v105, v105 clamp
v_exp_f32_e64 v106, v106 clamp
v_exp_f32_e64 v107, v107 clamp
v_max_f32 v44, s56, v44
v_max_f32 v45, s56, v45
v_max_f32 v46, s56, v46
v_max_f32 v47, s56, v47
v_pk_add_f32 v[44:45], v[44:45], v[104:105]
v_pk_add_f32 v[46:47], v[46:47], v[106:107]
v_cvt_pk_bf16_f32 v140, v44, v45
v_cvt_pk_bf16_f32 v141, v46, v47
buffer_store_dwordx4 v[138:141], v112, s[40:43], s58 offen sc1
v_pk_mul_f32 v[104:105], v[68:69], v[108:109]
v_pk_mul_f32 v[106:107], v[70:71], v[108:109]
v_exp_f32_e64 v104, v104 clamp
v_exp_f32_e64 v105, v105 clamp
v_exp_f32_e64 v106, v106 clamp
v_exp_f32_e64 v107, v107 clamp
v_max_f32 v68, s56, v68
v_max_f32 v69, s56, v69
v_max_f32 v70, s56, v70
v_max_f32 v71, s56, v71
v_pk_add_f32 v[68:69], v[68:69], v[104:105]
v_pk_add_f32 v[70:71], v[70:71], v[106:107]
v_cvt_pk_bf16_f32 v142, v68, v69
v_cvt_pk_bf16_f32 v143, v70, v71
v_pk_mul_f32 v[104:105], v[92:93], v[108:109]
v_pk_mul_f32 v[106:107], v[94:95], v[108:109]
v_exp_f32_e64 v104, v104 clamp
v_exp_f32_e64 v105, v105 clamp
v_exp_f32_e64 v106, v106 clamp
v_exp_f32_e64 v107, v107 clamp
v_max_f32 v92, s56, v92
v_max_f32 v93, s56, v93
v_max_f32 v94, s56, v94
v_max_f32 v95, s56, v95
v_pk_add_f32 v[92:93], v[92:93], v[104:105]
v_pk_add_f32 v[94:95], v[94:95], v[106:107]
v_cvt_pk_bf16_f32 v144, v92, v93
v_cvt_pk_bf16_f32 v145, v94, v95
buffer_store_dwordx4 v[142:145], v1, s[40:43], s58 offen sc1
s_add_u32 s58, s58, 1024
v_pk_mul_f32 v[104:105], v[24:25], v[108:109]
v_pk_mul_f32 v[106:107], v[26:27], v[108:109]
v_exp_f32_e64 v104, v104 clamp
v_exp_f32_e64 v105, v105 clamp
v_exp_f32_e64 v106, v106 clamp
v_exp_f32_e64 v107, v107 clamp
v_max_f32 v24, s56, v24
v_max_f32 v25, s56, v25
v_max_f32 v26, s56, v26
v_max_f32 v27, s56, v27
v_pk_add_f32 v[24:25], v[24:25], v[104:105]
v_pk_add_f32 v[26:27], v[26:27], v[106:107]
v_cvt_pk_bf16_f32 v146, v24, v25
v_cvt_pk_bf16_f32 v147, v26, v27
v_pk_mul_f32 v[104:105], v[48:49], v[108:109]
v_pk_mul_f32 v[106:107], v[50:51], v[108:109]
v_exp_f32_e64 v104, v104 clamp
v_exp_f32_e64 v105, v105 clamp
v_exp_f32_e64 v106, v106 clamp
v_exp_f32_e64 v107, v107 clamp
v_max_f32 v48, s56, v48
v_max_f32 v49, s56, v49
v_max_f32 v50, s56, v50
v_max_f32 v51, s56, v51
v_pk_add_f32 v[48:49], v[48:49], v[104:105]
v_pk_add_f32 v[50:51], v[50:51], v[106:107]
v_cvt_pk_bf16_f32 v148, v48, v49
v_cvt_pk_bf16_f32 v149, v50, v51
buffer_store_dwordx4 v[146:149], v112, s[40:43], s58 offen sc1
v_pk_mul_f32 v[104:105], v[72:73], v[108:109]
v_pk_mul_f32 v[106:107], v[74:75], v[108:109]
v_exp_f32_e64 v104, v104 clamp
v_exp_f32_e64 v105, v105 clamp
v_exp_f32_e64 v106, v106 clamp
v_exp_f32_e64 v107, v107 clamp
v_max_f32 v72, s56, v72
v_max_f32 v73, s56, v73
v_max_f32 v74, s56, v74
v_max_f32 v75, s56, v75
v_pk_add_f32 v[72:73], v[72:73], v[104:105]
v_pk_add_f32 v[74:75], v[74:75], v[106:107]
v_cvt_pk_bf16_f32 v150, v72, v73
v_cvt_pk_bf16_f32 v151, v74, v75
v_pk_mul_f32 v[104:105], v[96:97], v[108:109]
v_pk_mul_f32 v[106:107], v[98:99], v[108:109]
v_exp_f32_e64 v104, v104 clamp
v_exp_f32_e64 v105, v105 clamp
v_exp_f32_e64 v106, v106 clamp
v_exp_f32_e64 v107, v107 clamp
v_max_f32 v96, s56, v96
v_max_f32 v97, s56, v97
v_max_f32 v98, s56, v98
v_max_f32 v99, s56, v99
v_pk_add_f32 v[96:97], v[96:97], v[104:105]
v_pk_add_f32 v[98:99], v[98:99], v[106:107]
v_cvt_pk_bf16_f32 v152, v96, v97
v_cvt_pk_bf16_f32 v153, v98, v99
buffer_store_dwordx4 v[150:153], v1, s[40:43], s58 offen sc1
s_add_u32 s58, s58, 1024
v_pk_mul_f32 v[104:105], v[28:29], v[108:109]
v_pk_mul_f32 v[106:107], v[30:31], v[108:109]
v_exp_f32_e64 v104, v104 clamp
v_exp_f32_e64 v105, v105 clamp
v_exp_f32_e64 v106, v106 clamp
v_exp_f32_e64 v107, v107 clamp
v_max_f32 v28, s56, v28
v_max_f32 v29, s56, v29
v_max_f32 v30, s56, v30
v_max_f32 v31, s56, v31
v_pk_add_f32 v[28:29], v[28:29], v[104:105]
v_pk_add_f32 v[30:31], v[30:31], v[106:107]
v_cvt_pk_bf16_f32 v114, v28, v29
v_cvt_pk_bf16_f32 v115, v30, v31
v_pk_mul_f32 v[104:105], v[52:53], v[108:109]
v_pk_mul_f32 v[106:107], v[54:55], v[108:109]
v_exp_f32_e64 v104, v104 clamp
v_exp_f32_e64 v105, v105 clamp
v_exp_f32_e64 v106, v106 clamp
v_exp_f32_e64 v107, v107 clamp
v_max_f32 v52, s56, v52
v_max_f32 v53, s56, v53
v_max_f32 v54, s56, v54
v_max_f32 v55, s56, v55
v_pk_add_f32 v[52:53], v[52:53], v[104:105]
v_pk_add_f32 v[54:55], v[54:55], v[106:107]
v_cvt_pk_bf16_f32 v116, v52, v53
v_cvt_pk_bf16_f32 v117, v54, v55
buffer_store_dwordx4 v[114:117], v112, s[40:43], s58 offen sc1
v_pk_mul_f32 v[104:105], v[76:77], v[108:109]
v_pk_mul_f32 v[106:107], v[78:79], v[108:109]
v_exp_f32_e64 v104, v104 clamp
v_exp_f32_e64 v105, v105 clamp
v_exp_f32_e64 v106, v106 clamp
v_exp_f32_e64 v107, v107 clamp
v_max_f32 v76, s56, v76
v_max_f32 v77, s56, v77
v_max_f32 v78, s56, v78
v_max_f32 v79, s56, v79
v_pk_add_f32 v[76:77], v[76:77], v[104:105]
v_pk_add_f32 v[78:79], v[78:79], v[106:107]
v_cvt_pk_bf16_f32 v118, v76, v77
v_cvt_pk_bf16_f32 v119, v78, v79
v_pk_mul_f32 v[104:105], v[100:101], v[108:109]
v_pk_mul_f32 v[106:107], v[102:103], v[108:109]
v_exp_f32_e64 v104, v104 clamp
v_exp_f32_e64 v105, v105 clamp
v_exp_f32_e64 v106, v106 clamp
v_exp_f32_e64 v107, v107 clamp
v_max_f32 v100, s56, v100
v_max_f32 v101, s56, v101
v_max_f32 v102, s56, v102
v_max_f32 v103, s56, v103
v_pk_add_f32 v[100:101], v[100:101], v[104:105]
v_pk_add_f32 v[102:103], v[102:103], v[106:107]
v_cvt_pk_bf16_f32 v120, v100, v101
v_cvt_pk_bf16_f32 v121, v102, v103
buffer_store_dwordx4 v[118:121], v1, s[40:43], s58 offen sc1
s_add_u32 s58, s58, 1024
GM_exit:
s_endpgm
K1_aux:
s_load_dwordx2 s[6:7], s[0:1], 120
s_load_dwordx2 s[36:37], s[0:1], 16
s_load_dwordx4 s[92:95], s[0:1], 0
v_and_b32 v1, 63, v0
s_lshl_b32 s21, s16, 1
s_add_u32 s21, s21, s17
s_sub_u32 s21, s21, 30
v_lshlrev_b32 v5, 4, v1
s_mul_i32 s22, s21, 41472
s_lshl_b32 s23, s20, 10
s_add_u32 s22, s22, s23
v_lshrrev_b32 v2, 2, v1
v_mul_u32_u24 v2, 1152, v2
v_and_b32 v3, 3, v1
v_lshl_add_u32 v6, v3, 3, v2
s_mul_i32 s24, s20, 96
v_add_u32 v6, s24, v6
v_lshrrev_b32 v2, 5, v1
v_mul_u32_u24 v2, 20736, v2
v_bfe_u32 v3, v1, 4, 1
v_mul_u32_u24 v3, 1152, v3
v_add_u32 v2, v2, v3
v_and_b32 v3, 15, v1
v_lshl_add_u32 v7, v3, 1, v2
v_add_u32 v7, s24, v7
s_waitcnt lgkmcnt(0)
s_mov_b32 s12, s6
s_mov_b32 s13, s7
s_mov_b32 s14, 5570560
s_mov_b32 s15, 0x20000
s_mov_b32 s40, s36
s_mov_b32 s41, s37
s_mov_b32 s42, 663552
s_mov_b32 s43, 0x20000
v_mov_b32 v8, 0
v_mov_b32 v9, 0
v_mov_b32 v10, 0
v_mov_b32 v11, 0
s_load_dwordx2 s[44:45], s[0:1], 112
v_lshlrev_b32 v4, 4, v0
v_cmp_gt_u32 vcc, 228, v0
v_mov_b32 v3, 0x7f000000
s_nop 0
v_cndmask_b32 v4, v3, v4, vcc
s_mul_i32 s30, s21, 3648
s_add_u32 s30, s30, 5439488
buffer_store_dwordx4 v[8:11], v4, s[12:15], s30 offen sc1
s_add_u32 m0, s23, 0
s_add_u32 s25, s22, 0
buffer_load_dwordx4 v5, s[40:43], s25 offen lds
s_add_u32 m0, s23, 12288
s_add_u32 s25, s22, 12288
buffer_load_dwordx4 v5, s[40:43], s25 offen lds
s_add_u32 m0, s23, 24576
s_add_u32 s25, s22, 24576
buffer_load_dwordx4 v5, s[40:43], s25 offen lds
s_add_u32 m0, s23, 36864
s_add_u32 s25, s22, 36864
buffer_load_dwordx4 v5, s[40:43], s25 offen lds
s_waitcnt vmcnt(0)
s_barrier
s_mov_b32 s46, 256
s_mov_b32 s47, 0x20000
v_mov_b32 v2, 1
s_cmp_eq_u32 s20, 0
s_waitcnt lgkmcnt(0)
s_cbranch_scc0 AX_nosig
s_mov_b64 exec, 1
buffer_atomic_add v2, off, s[44:47], 0 offset:208
s_mov_b64 exec, -1
AX_nosig:
ds_read_b64_tr_b16 v[12:13], v6 offset:0
ds_read_b64_tr_b16 v[14:15], v6 offset:20736
ds_read_u16 v24, v7 offset:18432
ds_read_b64_tr_b16 v[16:17], v6 offset:32
ds_read_b64_tr_b16 v[18:19], v6 offset:20768
ds_read_u16 v25, v7 offset:18464
ds_read_b64_tr_b16 v[20:21], v6 offset:64
ds_read_b64_tr_b16 v[22:23], v6 offset:20800
ds_read_u16 v26, v7 offset:18496
s_mul_i32 s26, s20, 55296
s_lshl_b32 s27, s21, 10
s_add_u32 s27, s27, s26
s_add_u32 s27, s27, 4718592
s_lshr_b32 s28, s21, 3
s_lshl_b32 s28, s28, 10
s_and_b32 s29, s21, 7
s_lshl_b32 s29, s29, 1
s_add_u32 s28, s28, s29
s_add_u32 s28, s28, s26
s_add_u32 s28, s28, 4734976
s_waitcnt lgkmcnt(7)
buffer_store_dwordx4 v[12:15], v5, s[12:15], s27 offen sc1
s_waitcnt lgkmcnt(6)
buffer_store_short v24, v5, s[12:15], s28 offen sc1
s_add_u32 s27, s27, 18432
s_add_u32 s28, s28, 18432
s_waitcnt lgkmcnt(4)
buffer_store_dwordx4 v[16:19], v5, s[12:15], s27 offen sc1
s_waitcnt lgkmcnt(3)
buffer_store_short v25, v5, s[12:15], s28 offen sc1
s_add_u32 s27, s27, 18432
s_add_u32 s28, s28, 18432
s_waitcnt lgkmcnt(1)
buffer_store_dwordx4 v[20:23], v5, s[12:15], s27 offen sc1
s_waitcnt lgkmcnt(0)
buffer_store_short v26, v5, s[12:15], s28 offen sc1
s_endpgm
K1_end:
s_endpgm
.globl k2_kernel
.p2align 8
.type k2_kernel,@function
k2_kernel:
s_cmp_ge_u32 s2, 256
s_cbranch_scc1 K2_end
s_load_dwordx2 s[4:5], s[0:1], 104
s_load_dwordx2 s[6:7], s[0:1], 120
v_lshrrev_b32 v2, 6, v0
v_and_b32 v1, 63, v0
v_readfirstlane_b32 s20, v2
s_and_b32 s21, s2, 7
s_lshr_b32 s22, s2, 3
s_lshl_b32 s21, s21, 3
s_lshr_b32 s23, s22, 2
s_add_u32 s21, s21, s23
s_and_b32 s22, s22, 3
s_lshl_b32 s23, s23, 1
v_and_b32 v6, 15, v1
v_lshrrev_b32 v7, 4, v1
v_lshlrev_b32 v8, 4, v1
s_mul_i32 s24, s20, 7296
s_add_u32 s24, s24, 5439488
s_mul_i32 s25, s20, 4608
s_mul_i32 s35, s21, 36864
s_add_u32 s25, s25, s35
s_mul_i32 s27, s20, 6144
s_mul_i32 s26, s22, 9
s_add_u32 s26, s26, s20
s_mul_i32 s28, s26, 18432
s_add_u32 s28, s28, 4718592
s_waitcnt lgkmcnt(0)
s_mov_b32 s8, s6
s_mov_b32 s9, s7
s_mov_b32 s10, 5570560
s_mov_b32 s11, 0x20000
s_mov_b32 s12, s4
s_mov_b32 s13, s5
s_mov_b32 s14, 2359296
s_mov_b32 s15, 0x20000
s_cmp_eq_u32 s20, 8
s_cbranch_scc1 K2_w8
buffer_load_dwordx4 v[118:121], v8, s[8:11], s24 offen offset:0
buffer_load_dwordx4 v[122:125], v8, s[8:11], s24 offen offset:1024
buffer_load_dwordx4 v[126:129], v8, s[8:11], s24 offen offset:2048
buffer_load_dwordx4 v[130:133], v8, s[8:11], s24 offen offset:3072
s_add_u32 s24, s24, 4096
buffer_load_dwordx4 v[134:137], v8, s[8:11], s24 offen offset:0
buffer_load_dwordx4 v[138:141], v8, s[8:11], s24 offen offset:1024
buffer_load_dwordx4 v[142:145], v8, s[8:11], s24 offen offset:2048
buffer_load_dwordx4 v[146:149], v8, s[8:11], s24 offen offset:3072
s_add_u32 s29, s25, 0
s_add_u32 m0, s27, 0
s_nop 0
buffer_load_dwordx4 v8, s[8:11], s29 offen lds
s_add_u32 s29, s25, 1024
s_add_u32 m0, s27, 1024
s_nop 0
buffer_load_dwordx4 v8, s[8:11], s29 offen lds
s_add_u32 s29, s25, 2048
s_add_u32 m0, s27, 2048
s_nop 0
buffer_load_dwordx4 v8, s[8:11], s29 offen lds
s_add_u32 s29, s25, 3072
s_add_u32 m0, s27, 3072
s_nop 0
buffer_load_dwordx4 v8, s[8:11], s29 offen lds
s_add_u32 s29, s25, 4096
s_add_u32 m0, s27, 4096
s_nop 0
buffer_load_dwordx4 v8, s[8:11], s29 offen lds
v_mov_b32 v102, 0
v_mov_b32 v103, 0
v_mov_b32 v104, 0
v_mov_b32 v105, 0
v_mov_b32 v106, 0
v_mov_b32 v107, 0
v_mov_b32 v108, 0
v_mov_b32 v109, 0
v_mov_b32 v110, 0
v_mov_b32 v111, 0
v_mov_b32 v112, 0
v_mov_b32 v113, 0
v_mov_b32 v114, 0
v_mov_b32 v115, 0
v_mov_b32 v116, 0
v_mov_b32 v117, 0
s_lshl_b32 s34, s20, 12
s_add_u32 s34, s34, 49152
v_lshrrev_b32 v3, 1, v8
v_add_u32 v3, s34, v3
v_lshrrev_b32 v2, 2, v1
v_and_b32 v2, 3, v2
v_min_u32 v4, 2, v7
v_lshl_add_u32 v2, v4, 3, v2
v_lshlrev_b32 v2, 6, v2
v_and_b32 v5, 3, v1
v_lshl_add_u32 v2, v5, 3, v2
v_add_u32 v9, s27, v2
v_lshl_add_u32 v4, v7, 4, s34
v_mul_u32_u24 v2, 48, v6
v_add_u32 v10, v2, v4
v_bfe_u32 v2, v6, 2, 1
v_cmp_eq_u32 vcc, 2, v5
s_nop 1
v_cndmask_b32 v2, 2, v2, vcc
v_mul_u32_u24 v2, 48, v2
v_add_u32 v11, v2, v4
v_cmp_lt_u32 s[36:37], 1, v7
s_lshl_b32 s38, s20, 11
s_add_u32 s38, s38, 81920
v_add_u32 v13, s38, v8
s_lshr_b32 s38, s20, 2
s_lshl_b32 s38, s38, 10
s_and_b32 s39, s20, 3
s_lshl_b32 s39, s39, 2
s_add_u32 s38, s38, s39
s_add_u32 s38, s38, 98304
v_add_u32 v14, s38, v8
s_mov_b32 s62, 0xffffffff
s_mov_b32 s63, 0xffff
s_mov_b32 s64, 0x11551155
s_mov_b32 s65, 0x1155
s_mov_b32 s66, 0x66226622
s_mov_b32 s67, 0x6622
s_waitcnt vmcnt(12)
v_cvt_pk_bf16_f32 v118, v118, v119
v_cvt_pk_bf16_f32 v119, v120, v121
ds_write_b64 v3, v[118:119] offset:0
s_waitcnt vmcnt(11)
v_cvt_pk_bf16_f32 v122, v122, v123
v_cvt_pk_bf16_f32 v123, v124, v125
ds_write_b64 v3, v[122:123] offset:512
s_waitcnt vmcnt(10)
v_cvt_pk_bf16_f32 v126, v126, v127
v_cvt_pk_bf16_f32 v127, v128, v129
ds_write_b64 v3, v[126:127] offset:1024
s_waitcnt vmcnt(9)
v_cvt_pk_bf16_f32 v130, v130, v131
v_cvt_pk_bf16_f32 v131, v132, v133
ds_write_b64 v3, v[130:131] offset:1536
s_waitcnt vmcnt(8)
v_cvt_pk_bf16_f32 v134, v134, v135
v_cvt_pk_bf16_f32 v135, v136, v137
ds_write_b64 v3, v[134:135] offset:2048
s_waitcnt vmcnt(7)
v_cvt_pk_bf16_f32 v138, v138, v139
v_cvt_pk_bf16_f32 v139, v140, v141
ds_write_b64 v3, v[138:139] offset:2560
s_waitcnt vmcnt(6)
v_cvt_pk_bf16_f32 v142, v142, v143
v_cvt_pk_bf16_f32 v143, v144, v145
ds_write_b64 v3, v[142:143] offset:3072
s_waitcnt vmcnt(5)
v_cvt_pk_bf16_f32 v146, v146, v147
v_cvt_pk_bf16_f32 v147, v148, v149
ds_write_b64 v3, v[146:147] offset:3584
s_mov_b64 exec, s[62:63]
ds_read_b128 v[102:105], v10 offset:0
ds_read_b128 v[110:113], v10 offset:912
s_mov_b64 exec, s[64:65]
ds_read_b128 v[106:109], v11 offset:768
s_mov_b64 exec, s[66:67]
ds_read_b128 v[114:117], v11 offset:1680
s_mov_b64 exec, -1
s_waitcnt vmcnt(0)
ds_read_b64_tr_b16 v[118:119], v9 offset:0
ds_read_b64_tr_b16 v[120:121], v9 offset:256
ds_read_b64_tr_b16 v[122:123], v9 offset:1152
ds_read_b64_tr_b16 v[124:125], v9 offset:1408
ds_read_b64_tr_b16 v[126:127], v9 offset:32
ds_read_b64_tr_b16 v[128:129], v9 offset:288
ds_read_b64_tr_b16 v[130:131], v9 offset:1184
ds_read_b64_tr_b16 v[132:133], v9 offset:1440
s_waitcnt lgkmcnt(6)
v_mfma_f32_16x16x32_bf16 v[142:145], v[106:109], v[118:121], 0
v_mfma_f32_16x16x32_bf16 v[134:137], v[102:105], v[118:121], 0
s_waitcnt lgkmcnt(4)
v_mfma_f32_16x16x32_bf16 v[142:145], v[114:117], v[122:125], v[142:145]
v_mfma_f32_16x16x32_bf16 v[138:141], v[110:113], v[122:125], 0
s_waitcnt lgkmcnt(2)
v_mfma_f32_16x16x32_bf16 v[154:157], v[106:109], v[126:129], 0
v_mfma_f32_16x16x32_bf16 v[146:149], v[102:105], v[126:129], 0
s_waitcnt lgkmcnt(0)
v_mfma_f32_16x16x32_bf16 v[154:157], v[114:117], v[130:133], v[154:157]
v_mfma_f32_16x16x32_bf16 v[150:153], v[110:113], v[130:133], 0
s_mov_b64 exec, s[62:63]
ds_read_b128 v[102:105], v10 offset:1824
ds_read_b128 v[110:113], v10 offset:2736
s_mov_b64 exec, s[64:65]
ds_read_b128 v[106:109], v11 offset:2592
s_mov_b64 exec, s[66:67]
ds_read_b128 v[114:117], v11 offset:3504
s_mov_b64 exec, -1
ds_read_b64_tr_b16 v[118:119], v9 offset:2304
ds_read_b64_tr_b16 v[120:121], v9 offset:2560
ds_read_b64_tr_b16 v[122:123], v9 offset:3456
ds_read_b64_tr_b16 v[124:125], v9 offset:3712
ds_read_b64_tr_b16 v[126:127], v9 offset:2336
ds_read_b64_tr_b16 v[128:129], v9 offset:2592
ds_read_b64_tr_b16 v[130:131], v9 offset:3488
ds_read_b64_tr_b16 v[132:133], v9 offset:3744
v_add_f32 v20, 0x358637bd, v142
v_add_f32 v22, 0x358637bd, v143
v_rcp_f32 v20, v20
v_rcp_f32 v22, v22
v_pk_mul_f32 v[134:135], v[134:135], v[20:21] op_sel_hi:[1,0]
v_pk_mul_f32 v[136:137], v[136:137], v[20:21] op_sel_hi:[1,0]
v_pk_mul_f32 v[138:139], v[138:139], v[22:23] op_sel_hi:[1,0]
v_pk_mul_f32 v[140:141], v[140:141], v[22:23] op_sel_hi:[1,0]
v_cndmask_b32 v20, v20, v22, s[36:37]
v_mul_f32 v16, v144, v20
v_cvt_pk_bf16_f32 v142, v134, v135
v_cvt_pk_bf16_f32 v143, v136, v137
v_cvt_pk_bf16_f32 v144, v138, v139
v_cvt_pk_bf16_f32 v145, v140, v141
ds_write_b128 v13, v[142:145] offset:0
v_add_f32 v20, 0x358637bd, v154
v_add_f32 v22, 0x358637bd, v155
v_rcp_f32 v20, v20
v_rcp_f32 v22, v22
v_pk_mul_f32 v[146:147], v[146:147], v[20:21] op_sel_hi:[1,0]
v_pk_mul_f32 v[148:149], v[148:149], v[20:21] op_sel_hi:[1,0]
v_pk_mul_f32 v[150:151], v[150:151], v[22:23] op_sel_hi:[1,0]
v_pk_mul_f32 v[152:153], v[152:153], v[22:23] op_sel_hi:[1,0]
v_cndmask_b32 v20, v20, v22, s[36:37]
v_mul_f32 v18, v156, v20
v_cvt_pk_bf16_f32 v154, v146, v147
v_cvt_pk_bf16_f32 v155, v148, v149
v_cvt_pk_bf16_f32 v156, v150, v151
v_cvt_pk_bf16_f32 v157, v152, v153
ds_write_b128 v13, v[154:157] offset:18432
s_waitcnt lgkmcnt(8)
v_mfma_f32_16x16x32_bf16 v[142:145], v[106:109], v[118:121], 0
v_mfma_f32_16x16x32_bf16 v[134:137], v[102:105], v[118:121], 0
s_waitcnt lgkmcnt(6)
v_mfma_f32_16x16x32_bf16 v[142:145], v[114:117], v[122:125], v[142:145]
v_mfma_f32_16x16x32_bf16 v[138:141], v[110:113], v[122:125], 0
s_waitcnt lgkmcnt(4)
v_mfma_f32_16x16x32_bf16 v[154:157], v[106:109], v[126:129], 0
v_mfma_f32_16x16x32_bf16 v[146:149], v[102:105], v[126:129], 0
s_waitcnt lgkmcnt(2)
v_mfma_f32_16x16x32_bf16 v[154:157], v[114:117], v[130:133], v[154:157]
v_mfma_f32_16x16x32_bf16 v[150:153], v[110:113], v[130:133], 0
s_add_u32 s31, s28, 0
buffer_load_dwordx4 v[24:27], v8, s[8:11], s31 offen offset:0
buffer_load_dwordx4 v[28:31], v8, s[8:11], s31 offen offset:1024
buffer_load_dwordx4 v[32:35], v8, s[8:11], s31 offen offset:2048
v_add_f32 v20, 0x358637bd, v142
v_add_f32 v22, 0x358637bd, v143
v_rcp_f32 v20, v20
v_rcp_f32 v22, v22
v_pk_mul_f32 v[134:135], v[134:135], v[20:21] op_sel_hi:[1,0]
v_pk_mul_f32 v[136:137], v[136:137], v[20:21] op_sel_hi:[1,0]
v_pk_mul_f32 v[138:139], v[138:139], v[22:23] op_sel_hi:[1,0]
v_pk_mul_f32 v[140:141], v[140:141], v[22:23] op_sel_hi:[1,0]
v_cndmask_b32 v20, v20, v22, s[36:37]
v_mul_f32 v17, v144, v20
v_cvt_pk_bf16_f32 v142, v134, v135
v_cvt_pk_bf16_f32 v143, v136, v137
v_cvt_pk_bf16_f32 v144, v138, v139
v_cvt_pk_bf16_f32 v145, v140, v141
ds_write_b128 v13, v[142:145] offset:1024
buffer_load_dwordx4 v[36:39], v8, s[8:11], s31 offen offset:3072
s_add_u32 s31, s28, 4096
buffer_load_dwordx4 v[40:43], v8, s[8:11], s31 offen offset:0
v_add_f32 v20, 0x358637bd, v154
v_add_f32 v22, 0x358637bd, v155
v_rcp_f32 v20, v20
v_rcp_f32 v22, v22
v_pk_mul_f32 v[146:147], v[146:147], v[20:21] op_sel_hi:[1,0]
v_pk_mul_f32 v[148:149], v[148:149], v[20:21] op_sel_hi:[1,0]
v_pk_mul_f32 v[150:151], v[150:151], v[22:23] op_sel_hi:[1,0]
v_pk_mul_f32 v[152:153], v[152:153], v[22:23] op_sel_hi:[1,0]
v_cndmask_b32 v20, v20, v22, s[36:37]
v_mul_f32 v19, v156, v20
v_cvt_pk_bf16_f32 v154, v146, v147
v_cvt_pk_bf16_f32 v155, v148, v149
v_cvt_pk_bf16_f32 v156, v150, v151
v_cvt_pk_bf16_f32 v157, v152, v153
ds_write_b128 v13, v[154:157] offset:19456
buffer_load_dwordx4 v[44:47], v8, s[8:11], s31 offen offset:1024
buffer_load_dwordx4 v[48:51], v8, s[8:11], s31 offen offset:2048
v_cvt_pk_bf16_f32 v16, v16, v17
v_cvt_pk_bf16_f32 v18, v18, v19
ds_write_b32 v14, v16
ds_write_b32 v14, v18 offset:18432
s_waitcnt lgkmcnt(0)
s_branch K2_phaseB
K2_w8:
s_add_u32 s31, s28, 0
buffer_load_dwordx4 v[24:27], v8, s[8:11], s31 offen offset:0
buffer_load_dwordx4 v[28:31], v8, s[8:11], s31 offen offset:1024
buffer_load_dwordx4 v[32:35], v8, s[8:11], s31 offen offset:2048
buffer_load_dwordx4 v[36:39], v8, s[8:11], s31 offen offset:3072
s_add_u32 s31, s28, 4096
buffer_load_dwordx4 v[40:43], v8, s[8:11], s31 offen offset:0
buffer_load_dwordx4 v[44:47], v8, s[8:11], s31 offen offset:1024
buffer_load_dwordx4 v[48:51], v8, s[8:11], s31 offen offset:2048
K2_phaseB:
s_barrier
s_lshl_b32 s29, s26, 10
s_add_u32 s29, s29, s35
s_add_u32 s29, s29, 2359296
s_lshl_b32 s33, s20, 10
s_add_u32 m0, s33, 118784
s_nop 0
buffer_load_dwordx4 v8, s[8:11], s29 offen lds
v_lshlrev_b32 v4, 2, v6
s_lshl_b32 s30, s21, 7
s_add_u32 s30, s30, 5505024
buffer_load_dword v100, v4, s[8:11], s30 offen
buffer_load_dword v101, v4, s[8:11], s30 offen offset:64
v_add_u32 v5, 81920, v8
ds_read_b128 v[110:113], v5 offset:0
ds_read_b128 v[114:117], v5 offset:18432
ds_read_b128 v[118:121], v5 offset:1024
ds_read_b128 v[122:125], v5 offset:19456
buffer_load_dwordx4 v[52:55], v8, s[8:11], s31 offen offset:3072
s_add_u32 s31, s28, 8192
buffer_load_dwordx4 v[56:59], v8, s[8:11], s31 offen offset:0
ds_read_b128 v[126:129], v5 offset:2048
ds_read_b128 v[130:133], v5 offset:20480
s_waitcnt vmcnt(11) lgkmcnt(5)
v_mfma_f32_16x16x32_bf16 v[102:105], v[24:27], v[110:113], 0
s_waitcnt lgkmcnt(4)
v_mfma_f32_16x16x32_bf16 v[106:109], v[24:27], v[114:117], 0
buffer_load_dwordx4 v[60:63], v8, s[8:11], s31 offen offset:1024
buffer_load_dwordx4 v[64:67], v8, s[8:11], s31 offen offset:2048
ds_read_b128 v[110:113], v5 offset:3072
ds_read_b128 v[114:117], v5 offset:21504
s_waitcnt vmcnt(12) lgkmcnt(5)
v_mfma_f32_16x16x32_bf16 v[102:105], v[28:31], v[118:121], v[102:105]
s_waitcnt lgkmcnt(4)
v_mfma_f32_16x16x32_bf16 v[106:109], v[28:31], v[122:125], v[106:109]
buffer_load_dwordx4 v[68:71], v8, s[8:11], s31 offen offset:3072
s_add_u32 s31, s28, 12288
buffer_load_dwordx4 v[72:75], v8, s[8:11], s31 offen offset:0
ds_read_b128 v[118:121], v5 offset:4096
ds_read_b128 v[122:125], v5 offset:22528
s_waitcnt vmcnt(13) lgkmcnt(5)
v_mfma_f32_16x16x32_bf16 v[102:105], v[32:35], v[126:129], v[102:105]
s_waitcnt lgkmcnt(4)
v_mfma_f32_16x16x32_bf16 v[106:109], v[32:35], v[130:133], v[106:109]
buffer_load_dwordx4 v[76:79], v8, s[8:11], s31 offen offset:1024
buffer_load_dwordx4 v[80:83], v8, s[8:11], s31 offen offset:2048
ds_read_b128 v[126:129], v5 offset:5120
ds_read_b128 v[130:133], v5 offset:23552
s_waitcnt vmcnt(14) lgkmcnt(5)
v_mfma_f32_16x16x32_bf16 v[102:105], v[36:39], v[110:113], v[102:105]
s_waitcnt lgkmcnt(4)
v_mfma_f32_16x16x32_bf16 v[106:109], v[36:39], v[114:117], v[106:109]
buffer_load_dwordx4 v[84:87], v8, s[8:11], s31 offen offset:3072
s_add_u32 s31, s28, 16384
buffer_load_dwordx4 v[88:91], v8, s[8:11], s31 offen offset:0
ds_read_b128 v[110:113], v5 offset:6144
ds_read_b128 v[114:117], v5 offset:24576
s_waitcnt vmcnt(15) lgkmcnt(5)
v_mfma_f32_16x16x32_bf16 v[102:105], v[40:43], v[118:121], v[102:105]
s_waitcnt lgkmcnt(4)
v_mfma_f32_16x16x32_bf16 v[106:109], v[40:43], v[122:125], v[106:109]
buffer_load_dwordx4 v[92:95], v8, s[8:11], s31 offen offset:1024
ds_read_b128 v[118:121], v5 offset:7168
ds_read_b128 v[122:125], v5 offset:25600
s_waitcnt vmcnt(15) lgkmcnt(5)
v_mfma_f32_16x16x32_bf16 v[102:105], v[44:47], v[126:129], v[102:105]
s_waitcnt lgkmcnt(4)
v_mfma_f32_16x16x32_bf16 v[106:109], v[44:47], v[130:133], v[106:109]
ds_read_b128 v[126:129], v5 offset:8192
ds_read_b128 v[130:133], v5 offset:26624
s_waitcnt vmcnt(14) lgkmcnt(5)
v_mfma_f32_16x16x32_bf16 v[102:105], v[48:51], v[110:113], v[102:105]
s_waitcnt lgkmcnt(4)
v_mfma_f32_16x16x32_bf16 v[106:109], v[48:51], v[114:117], v[106:109]
ds_read_b128 v[110:113], v5 offset:9216
ds_read_b128 v[114:117], v5 offset:27648
s_waitcnt vmcnt(10) lgkmcnt(5)
v_mfma_f32_16x16x32_bf16 v[102:105], v[52:55], v[118:121], v[102:105]
s_waitcnt lgkmcnt(4)
v_mfma_f32_16x16x32_bf16 v[106:109], v[52:55], v[122:125], v[106:109]
ds_read_b128 v[118:121], v5 offset:10240
ds_read_b128 v[122:125], v5 offset:28672
s_waitcnt vmcnt(9) lgkmcnt(5)
v_mfma_f32_16x16x32_bf16 v[102:105], v[56:59], v[126:129], v[102:105]
s_waitcnt lgkmcnt(4)
v_mfma_f32_16x16x32_bf16 v[106:109], v[56:59], v[130:133], v[106:109]
ds_read_b128 v[126:129], v5 offset:11264
ds_read_b128 v[130:133], v5 offset:29696
s_waitcnt vmcnt(8) lgkmcnt(5)
v_mfma_f32_16x16x32_bf16 v[102:105], v[60:63], v[110:113], v[102:105]
s_waitcnt lgkmcnt(4)
v_mfma_f32_16x16x32_bf16 v[106:109], v[60:63], v[114:117], v[106:109]
ds_read_b128 v[110:113], v5 offset:12288
ds_read_b128 v[114:117], v5 offset:30720
s_waitcnt vmcnt(7) lgkmcnt(5)
v_mfma_f32_16x16x32_bf16 v[102:105], v[64:67], v[118:121], v[102:105]
s_waitcnt lgkmcnt(4)
v_mfma_f32_16x16x32_bf16 v[106:109], v[64:67], v[122:125], v[106:109]
ds_read_b128 v[118:121], v5 offset:13312
ds_read_b128 v[122:125], v5 offset:31744
s_waitcnt vmcnt(6) lgkmcnt(5)
v_mfma_f32_16x16x32_bf16 v[102:105], v[68:71], v[126:129], v[102:105]
s_waitcnt lgkmcnt(4)
v_mfma_f32_16x16x32_bf16 v[106:109], v[68:71], v[130:133], v[106:109]
ds_read_b128 v[126:129], v5 offset:14336
ds_read_b128 v[130:133], v5 offset:32768
s_waitcnt vmcnt(5) lgkmcnt(5)
v_mfma_f32_16x16x32_bf16 v[102:105], v[72:75], v[110:113], v[102:105]
s_waitcnt lgkmcnt(4)
v_mfma_f32_16x16x32_bf16 v[106:109], v[72:75], v[114:117], v[106:109]
ds_read_b128 v[110:113], v5 offset:15360
ds_read_b128 v[114:117], v5 offset:33792
s_waitcnt vmcnt(4) lgkmcnt(5)
v_mfma_f32_16x16x32_bf16 v[102:105], v[76:79], v[118:121], v[102:105]
s_waitcnt lgkmcnt(4)
v_mfma_f32_16x16x32_bf16 v[106:109], v[76:79], v[122:125], v[106:109]
ds_read_b128 v[118:121], v5 offset:16384
ds_read_b128 v[122:125], v5 offset:34816
s_waitcnt vmcnt(3) lgkmcnt(5)
v_mfma_f32_16x16x32_bf16 v[102:105], v[80:83], v[126:129], v[102:105]
s_waitcnt lgkmcnt(4)
v_mfma_f32_16x16x32_bf16 v[106:109], v[80:83], v[130:133], v[106:109]
ds_read_b128 v[126:129], v5 offset:17408
ds_read_b128 v[130:133], v5 offset:35840
s_waitcnt vmcnt(2) lgkmcnt(5)
v_mfma_f32_16x16x32_bf16 v[102:105], v[84:87], v[110:113], v[102:105]
s_waitcnt lgkmcnt(4)
v_mfma_f32_16x16x32_bf16 v[106:109], v[84:87], v[114:117], v[106:109]
s_waitcnt vmcnt(1) lgkmcnt(3)
v_mfma_f32_16x16x32_bf16 v[102:105], v[88:91], v[118:121], v[102:105]
s_waitcnt lgkmcnt(2)
v_mfma_f32_16x16x32_bf16 v[106:109], v[88:91], v[122:125], v[106:109]
s_waitcnt vmcnt(0) lgkmcnt(1)
v_mfma_f32_16x16x32_bf16 v[102:105], v[92:95], v[126:129], v[102:105]
s_waitcnt lgkmcnt(0)
v_mfma_f32_16x16x32_bf16 v[106:109], v[92:95], v[130:133], v[106:109]
v_lshrrev_b32 v2, 2, v1
v_lshlrev_b32 v2, 6, v2
v_and_b32 v4, 3, v1
v_lshl_add_u32 v2, v4, 3, v2
v_add_u32 v2, s33, v2
v_add_u32 v2, 118784, v2
s_waitcnt vmcnt(0)
ds_read_b64_tr_b16 v[96:97], v2
ds_read_b64_tr_b16 v[98:99], v2 offset:32
v_mul_u32_u24 v2, 1152, v6
v_lshl_add_u32 v2, v7, 3, v2
s_mul_i32 s60, s21, 36864
s_lshl_b32 s61, s26, 5
s_add_u32 s60, s60, s61
s_waitcnt lgkmcnt(1)
v_lshlrev_b32 v138, 16, v96
v_and_b32 v139, 0xffff0000, v96
v_lshlrev_b32 v140, 16, v97
v_and_b32 v141, 0xffff0000, v97
v_sub_f32 v102, v102, v138
v_fma_f32 v102, v100, v102, v138
v_sub_f32 v103, v103, v139
v_fma_f32 v103, v100, v103, v139
v_sub_f32 v104, v104, v140
v_fma_f32 v104, v100, v104, v140
v_sub_f32 v105, v105, v141
v_fma_f32 v105, v100, v105, v141
v_cvt_pk_bf16_f32 v142, v102, v103
v_cvt_pk_bf16_f32 v143, v104, v105
buffer_store_dwordx2 v[142:143], v2, s[12:15], s60 offen
s_add_u32 s60, s60, 18432
s_waitcnt lgkmcnt(0)
v_lshlrev_b32 v138, 16, v98
v_and_b32 v139, 0xffff0000, v98
v_lshlrev_b32 v140, 16, v99
v_and_b32 v141, 0xffff0000, v99
v_sub_f32 v106, v106, v138
v_fma_f32 v106, v101, v106, v138
v_sub_f32 v107, v107, v139
v_fma_f32 v107, v101, v107, v139
v_sub_f32 v108, v108, v140
v_fma_f32 v108, v101, v108, v140
v_sub_f32 v109, v109, v141
v_fma_f32 v109, v101, v109, v141
v_cvt_pk_bf16_f32 v144, v106, v107
v_cvt_pk_bf16_f32 v145, v108, v109
buffer_store_dwordx2 v[144:145], v2, s[12:15], s60 offen
K2_end:
s_endpgm
.section .rodata,"a"
.p2align 6
.amdhsa_kernel k1_kernel
  .amdhsa_next_free_vgpr 168
  .amdhsa_next_free_sgpr 102
  .amdhsa_accum_offset 168
  .amdhsa_group_segment_fixed_size 0
  .amdhsa_kernarg_size 128
  .amdhsa_user_sgpr_count 2
  .amdhsa_user_sgpr_kernarg_segment_ptr 1
  .amdhsa_system_sgpr_workgroup_id_x 1
.end_amdhsa_kernel
.p2align 6
.amdhsa_kernel k2_kernel
  .amdhsa_next_free_vgpr 158
  .amdhsa_next_free_sgpr 102
  .amdhsa_accum_offset 160
  .amdhsa_group_segment_fixed_size 0
  .amdhsa_kernarg_size 128
  .amdhsa_user_sgpr_count 2
  .amdhsa_user_sgpr_kernarg_segment_ptr 1
  .amdhsa_system_sgpr_workgroup_id_x 1
.end_amdhsa_kernel
```
